```python
import torch

def _softmax(x, axis=-1):
    return torch.softmax(x, dim=axis)
def _gelu(x):
    return torch.nn.functional.gelu(x, approximate="tanh")
def _silu(x):
    return torch.nn.functional.silu(x)
def _sigmoid(x):
    return torch.sigmoid(x)
def _layernorm(x, axis=-1, eps=1e-5):
    m = x.mean(dim=axis, keepdim=True)
    v = x.var(dim=axis, keepdim=True, unbiased=False)
    return (x - m) / torch.sqrt(v + eps)
def _scatter_add(tgt, idx, src, axis=0):
    return tgt.clone().index_add_(axis, idx, src)
def _segment_sum(src, seg, n):
    out = torch.zeros((n,) + src.shape[1:], dtype=src.dtype)
    return out.index_add_(0, seg, src)
def _pad(x, pw):
    flat = tuple(v for pair in reversed(pw) for v in pair)
    return torch.nn.functional.pad(x, flat)

kernel_name = 'parallel_sum__mha_block_cached__geglu_ffn__decode'

def setup_inputs():

    _w = (lambda a: (lambda t: t.to(torch.bfloat16) if t.is_floating_point() else t)(torch.as_tensor(a)))
    def _A_setup():
        B, Sq, D = 1, 1, 448
        H, Sk, Dh = 16, 32768, 256
        return {
            "x": _w((lambda *s: torch.randn(*s, dtype=torch.bfloat16) * 0.05)(B, Sq, D)),
            "k_cache": _w((lambda *s: torch.randn(*s, dtype=torch.bfloat16) * 3.2)(B, H, Sk, Dh)),
            "v_cache": _w((lambda *s: torch.randn(*s, dtype=torch.bfloat16) * 1.6)(B, H, Sk, Dh)),
            "wq": _w((lambda *s: torch.randn(*s, dtype=torch.bfloat16) * 3.2)(D, H * Dh) * (D ** -0.5)),
            "wo": _w((lambda *s: torch.randn(*s, dtype=torch.bfloat16) * 1.6)(H * Dh, D) * ((H * Dh) ** -0.5)),
        }
    _A_in = _A_setup()

    def _B_setup():
        B, S, D, F = 1, 1, 448, 1792
        return {
            "x": _w((lambda *s: torch.randn(*s, dtype=torch.bfloat16) * 0.05)(B, S, D)),
            "w_gate": _w((lambda *s: torch.randn(*s, dtype=torch.bfloat16) * 0.05)(D, F)),
            "w_up": _w((lambda *s: torch.randn(*s, dtype=torch.bfloat16) * 0.05)(D, F)),
            "w_down": _w((lambda *s: torch.randn(*s, dtype=torch.bfloat16) * 0.05)(F, D)),
        }
    _B_in = _B_setup()

    return {
        "A_x": _A_in["x"],
        "A_k_cache": _A_in["k_cache"],
        "A_v_cache": _A_in["v_cache"],
        "A_wq": _A_in["wq"],
        "A_wo": _A_in["wo"],
        "B_x": _B_in["x"],
        "B_w_gate": _B_in["w_gate"],
        "B_w_up": _B_in["w_up"],
        "B_w_down": _B_in["w_down"],
    }

def reference(A_x, A_k_cache, A_v_cache, A_wq, A_wo, B_x, B_w_gate, B_w_up, B_w_down):
    def _A_ref(x, k_cache, v_cache, wq, wo):
        B, Sq, D = x.shape
        H, Dh = 16, 256
        q = (lambda x, *d: x.permute(*d))((x @ wq).reshape(B, Sq, H, Dh), 0, 2, 1, 3)
        scores = torch.einsum("bhqd,bhkd->bhqk", q, k_cache) * (Dh ** -0.5)
        p = _softmax(scores, axis=-1)
        o = torch.einsum("bhqk,bhkd->bhqd", p, v_cache)
        return (lambda x, *d: x.permute(*d))(o, 0, 2, 1, 3).reshape(B, Sq, H * Dh) @ wo

    def _B_ref(x, w_gate, w_up, w_down):
        return (_gelu(x @ w_gate) * (x @ w_up)) @ w_down

    x = A_x
    xn = _layernorm(x, axis=-1)
    return x + _A_ref(xn, A_k_cache, A_v_cache, A_wq, A_wo) + _B_ref(xn, B_w_gate, B_w_up, B_w_down)
```

```asm
; @launch grid=(256,1,1) block=(256,1,1) lds=9216
.amdgcn_target "amdgcn-amd-amdhsa--gfx950"
.text
.globl parallel_sum__mha_block_cached__geglu_ffn__decode_kernel
.p2align 8
.type parallel_sum__mha_block_cached__geglu_ffn__decode_kernel,@function
parallel_sum__mha_block_cached__geglu_ffn__decode_kernel:
s_cmp_ge_u32 s2, 256
s_cbranch_scc1 main_done
s_load_dwordx16 s[16:31], s[0:1], 0
s_load_dwordx8 s[32:39], s[0:1], 64
s_memtime s[100:101]
v_lshrrev_b32 v1, 6, v0
s_nop 0
v_readfirstlane_b32 s3, v1
v_and_b32 v1, 63, v0
s_getpc_b64 s[98:99]
ipf_pc:
s_lshr_b32 s5, s2, 3
s_lshl_b32 s5, s5, 10
s_min_u32 s5, s5, code_end-ipf_pc-1024
v_lshl_add_u32 v63, v1, 4, s5
s_cmp_lg_u32 s3, 3
s_cbranch_scc1 noipf
global_load_dwordx4 v[28:31], v63, s[98:99]
noipf:
s_lshr_b32 s5, s2, 4
s_and_b32 s6, s2, 15
v_lshlrev_b32 v17, 4, v1
v_lshrrev_b32 v18, 3, v1
v_and_b32 v14, 7, v1
v_lshlrev_b32 v14, 4, v14
v_lshl_add_u32 v19, v18, 13, v14
v_mul_u32_u24 v47, 3584, v18
v_add_u32 v47, v47, v14
v_mov_b32 v15, 0x80000000
v_cmp_gt_u32 vcc, 32, v1
s_nop 1
v_cndmask_b32 v14, v15, v19, vcc
v_cmp_gt_u32 vcc, 48, v1
s_nop 1
v_cndmask_b32 v16, v15, v47, vcc
v_lshlrev_b32 v18, 1, v18
v_and_b32 v2, 31, v1
v_lshlrev_b32 v2, 4, v2
v_lshrrev_b32 v3, 5, v1
v_lshlrev_b32 v3, 15, v3
v_add_u32 v2, v2, v3
v_add_u32 v3, 0x10000, v2
s_bfe_u32 s7, s2, 0x20002
s_mul_i32 s8, s7, 112
s_mul_i32 s9, s3, 28
s_add_u32 s8, s8, s9
s_lshl_b32 s9, s8, 1
s_lshl_b32 s8, s8, 13
s_lshl_b32 s10, s5, 9
s_add_u32 s8, s8, s10
s_and_b32 s10, s2, 3
s_lshl_b32 s10, s10, 7
s_add_u32 s8, s8, s10
s_lshr_b32 s11, s2, 3
s_and_b32 s13, s2, 7
s_mul_i32 s12, s13, 56
s_mul_i32 s14, s3, 14
s_add_u32 s12, s12, s14
s_mul_i32 s14, s12, 3584
s_lshl_b32 s12, s12, 1
s_lshl_b32 s15, s11, 7
s_add_u32 s14, s14, s15
s_lshl_b32 s83, s5, 24
s_bitcmp1_b32 s2, 3
s_cselect_b32 s15, 0x84000, 0
s_xor_b32 s83, s83, s15
s_lshr_b32 s10, s2, 1
s_lshr_b32 s15, s2, 7
s_xor_b32 s10, s10, s15
s_andn2_b32 s10, 1, s10
s_lshl_b32 s10, s10, 12
s_xor_b32 s83, s83, s10
s_lshr_b32 s10, s2, 6
s_xor_b32 s10, s10, s2
s_and_b32 s10, s10, 1
s_lshl_b32 s10, s10, 14
s_xor_b32 s83, s83, s10
s_bfe_u32 s4, s2, 0x10002
s_xor_b32 s10, s4, s11
s_and_b32 s10, s10, 1
s_lshl_b32 s10, s10, 13
s_xor_b32 s90, s83, s10
s_bitcmp1_b32 s3, 0
s_cselect_b32 s10, 0x484000, 0
s_xor_b32 s90, s90, s10
s_bitcmp1_b32 s3, 1
s_cselect_b32 s10, 0x901000, 0
s_xor_b32 s90, s90, s10
s_bfe_u32 s10, s11, 0x10001
s_lshl_b32 s10, s10, 14
s_xor_b32 s90, s90, s10
s_bfe_u32 s10, s11, 0x10002
s_lshl_b32 s10, s10, 12
s_xor_b32 s90, s90, s10
s_lshl_b32 s74, s11, 23
s_and_b32 s75, s2, 3
s_lshl_b32 s75, s75, 21
s_or_b32 s74, s74, s75
s_bfe_u32 s75, s2, 0x10002
s_lshl_b32 s75, s75, 11
s_or_b32 s74, s74, s75
s_or_b32 s74, s74, 0x40000
s_and_b32 s76, s3, 1
s_lshl_b32 s75, s76, 13
s_or_b32 s74, s74, s75
s_getreg_b32 s79, hwreg(HW_REG_XCC_ID)
s_bfe_u32 s79, s79, 0x10002
s_xor_b32 s76, s76, s79
s_xor_b32 s76, s76, s2
s_and_b32 s76, s76, 1
s_mov_b32 s10, 3112960
s_waitcnt lgkmcnt(0)
s_mov_b32 s92, s90
s_cmp_lt_u32 s3, 2
s_cselect_b32 s72, s18, s20
s_cselect_b32 s73, s19, s21
s_lshr_b32 s100, s100, 3
s_mul_i32 s100, s100, 0x9e3779b1
s_lshr_b32 s100, s100, 8
s_and_b32 s100, s100, 0x1bd780
s_or_b32 s74, s74, s100
s_xor_b32 s75, s74, 0x400
s_load_dword s78, s[72:73], s75
s_load_dword s89, s[38:39], s10
s_mov_b32 s40, s18
s_mov_b32 s41, s19
s_mov_b32 s42, 0x10000000
s_mov_b32 s43, 0x20000
s_mov_b32 s52, s16
s_mov_b32 s53, s17
s_mov_b32 s54, 0x380
s_mov_b32 s55, 0x20000
s_mov_b32 s56, s22
s_mov_b32 s57, s23
s_mov_b32 s58, 0x380000
s_mov_b32 s59, 0x20000
buffer_load_dwordx4 v[60:63], v17, s[52:55], 0 offen
buffer_load_ushort v40, v18, s[52:55], s9 offen offset:0
buffer_load_ushort v41, v18, s[52:55], s9 offen offset:16
buffer_load_ushort v42, v18, s[52:55], s9 offen offset:32
buffer_load_ushort v43, v18, s[52:55], s9 offen offset:48
buffer_load_dwordx4 v[160:163], v19, s[56:59], s8 offen nt
s_add_u32 s8, s8, 65536
buffer_load_dwordx4 v[164:167], v19, s[56:59], s8 offen nt
s_add_u32 s8, s8, 65536
buffer_load_dwordx4 v[168:171], v19, s[56:59], s8 offen nt
s_add_u32 s8, s8, 65536
buffer_load_dwordx4 v[172:175], v14, s[56:59], s8 offen nt
s_barrier
buffer_load_dwordx4 v[64:67], v2, s[40:43], s92 offen offset:0 nt
buffer_load_dwordx4 v[68:71], v3, s[40:43], s92 offen offset:0 nt
buffer_load_dwordx4 v[72:75], v2, s[40:43], s92 offen offset:512 nt
buffer_load_dwordx4 v[76:79], v3, s[40:43], s92 offen offset:512 nt
buffer_load_dwordx4 v[80:83], v2, s[40:43], s92 offen offset:2048 nt
buffer_load_dwordx4 v[84:87], v3, s[40:43], s92 offen offset:2048 nt
s_mov_b32 s60, s28
s_mov_b32 s61, s29
s_mov_b32 s62, 0x188000
s_mov_b32 s63, 0x20000
s_mov_b32 s64, s30
s_mov_b32 s65, s31
s_mov_b32 s66, 0x188000
s_mov_b32 s67, 0x20000
s_mov_b32 s68, s32
s_mov_b32 s69, s33
s_mov_b32 s70, 0x188000
s_mov_b32 s71, 0x20000
s_mov_b32 s44, s20
s_mov_b32 s45, s21
s_mov_b32 s46, 0x10000000
s_mov_b32 s47, 0x20000
s_mov_b32 s48, s38
s_mov_b32 s49, s39
s_mov_b32 s50, 0x340000
s_mov_b32 s51, 0x20000
s_lshl_b32 s8, s5, 13
s_add_u32 s8, s8, 2883584
s_lshl_b32 s9, s3, 9
s_add_u32 s15, s8, s9
s_lshl_b32 s9, s7, 11
s_add_u32 s8, s8, s9
s_and_b32 s9, s2, 3
s_lshl_b32 s9, s9, 9
s_add_u32 s7, s8, s9
v_and_b32 v13, 7, v1
v_and_b32 v10, 56, v1
v_lshl_add_u32 v11, v13, 6, v10
v_lshl_add_u32 v46, v13, 10, v10
v_mul_u32_u24 v19, 4352, v1
v_cmp_gt_u32 vcc, 8, v1
s_nop 1
v_cndmask_b32 v19, v15, v19, vcc
s_cmp_eq_u32 s3, 0
s_cselect_b64 vcc, -1, 0
v_cndmask_b32 v10, v15, v11, vcc
v_mov_b32 v12, 0
ds_write_b32 v12, v12 offset:544
s_waitcnt vmcnt(14)
v_readfirstlane_b32 s77, v60
s_nop 0
s_lshl_b32 s77, s77, 16
v_mov_b32 v12, 0
v_mov_b32 v13, 0
s_mov_b32 exec_hi, 0x00ffffff
v_lshlrev_b32 v32, 16, v60
v_and_b32 v33, 0xffff0000, v60
v_lshlrev_b32 v34, 16, v61
v_and_b32 v35, 0xffff0000, v61
v_lshlrev_b32 v36, 16, v62
v_and_b32 v37, 0xffff0000, v62
v_lshlrev_b32 v38, 16, v63
v_and_b32 v39, 0xffff0000, v63
v_subrev_f32 v32, s77, v32
v_subrev_f32 v33, s77, v33
v_subrev_f32 v34, s77, v34
v_subrev_f32 v35, s77, v35
v_subrev_f32 v36, s77, v36
v_subrev_f32 v37, s77, v37
v_subrev_f32 v38, s77, v38
v_subrev_f32 v39, s77, v39
v_add_f32 v12, v32, v33
v_mul_f32 v13, v32, v32
v_add_f32 v11, v34, v35
v_mul_f32 v23, v33, v33
v_add_f32 v20, v36, v37
v_fmac_f32 v13, v34, v34
v_add_f32 v21, v38, v39
v_fmac_f32 v23, v35, v35
v_add_f32 v12, v12, v11
v_fmac_f32 v13, v36, v36
v_add_f32 v20, v20, v21
v_fmac_f32 v23, v37, v37
v_fmac_f32 v13, v38, v38
v_add_f32 v12, v12, v20
v_fmac_f32 v23, v39, v39
v_add_f32 v13, v13, v23
s_mov_b32 exec_hi, -1
v_mov_b32 v21, 0x43e00000
v_mov_b32 v22, 0x3b124925
v_add_f32_dpp v12, v12, v12 row_ror:8 row_mask:0xf bank_mask:0xf
v_add_f32_dpp v13, v13, v13 row_ror:8 row_mask:0xf bank_mask:0xf
s_nop 0
v_add_f32_dpp v12, v12, v12 row_ror:4 row_mask:0xf bank_mask:0xf
v_add_f32_dpp v13, v13, v13 row_ror:4 row_mask:0xf bank_mask:0xf
s_nop 0
v_add_f32_dpp v12, v12, v12 row_ror:2 row_mask:0xf bank_mask:0xf
v_add_f32_dpp v13, v13, v13 row_ror:2 row_mask:0xf bank_mask:0xf
s_nop 0
v_add_f32_dpp v12, v12, v12 row_ror:1 row_mask:0xf bank_mask:0xf
v_add_f32_dpp v13, v13, v13 row_ror:1 row_mask:0xf bank_mask:0xf
v_mov_b32 v11, v12
v_mov_b32 v23, v13
s_nop 0
v_permlane16_swap_b32 v12, v11
v_permlane16_swap_b32 v13, v23
v_add_f32 v12, v12, v11
v_add_f32 v13, v13, v23
v_mov_b32 v11, v12
v_mov_b32 v23, v13
s_nop 0
v_permlane32_swap_b32 v12, v11
v_permlane32_swap_b32 v13, v23
v_add_f32 v12, v12, v11
v_add_f32 v13, v13, v23
v_mul_f32 v11, v12, v22
v_fma_f32 v20, -v11, v21, v12
v_fma_f32 v20, v20, v22, v11
v_fma_f32 v13, -v12, v20, v13
v_add_f32 v20, s77, v20
v_mul_f32 v11, v13, v22
v_fma_f32 v32, -v11, v21, v13
v_fma_f32 v32, v32, v22, v11
v_cvt_pk_bf16_f32 v20, v20, v20
v_max_f32 v32, 0, v32
v_and_b32 v20, 0xffff0000, v20
v_cvt_pk_bf16_f32 v32, v32, v32
v_and_b32 v32, 0xffff0000, v32
v_add_f32 v32, 0x3727c5ac, v32
v_cvt_pk_bf16_f32 v32, v32, v32
v_and_b32 v32, 0xffff0000, v32
v_sqrt_f32 v12, v32
v_rsq_f32 v13, v32
v_fma_f32 v33, -v12, v12, v32
v_mul_f32 v13, 0.5, v13
v_fma_f32 v12, v33, v13, v12
v_cvt_pk_bf16_f32 v21, v12, v12
v_and_b32 v21, 0xffff0000, v21
v_rcp_f32 v22, v21
s_waitcnt vmcnt(10)
v_lshlrev_b32 v40, 16, v40
v_lshlrev_b32 v41, 16, v41
v_lshlrev_b32 v42, 16, v42
v_lshlrev_b32 v43, 16, v43
v_sub_f32 v40, v40, v20
v_sub_f32 v41, v41, v20
v_sub_f32 v42, v42, v20
v_sub_f32 v43, v43, v20
v_cvt_pk_bf16_f32 v40, v40, v40
v_cvt_pk_bf16_f32 v41, v41, v41
v_cvt_pk_bf16_f32 v42, v42, v42
v_cvt_pk_bf16_f32 v43, v43, v43
v_and_b32 v40, 0xffff0000, v40
v_and_b32 v41, 0xffff0000, v41
v_and_b32 v42, 0xffff0000, v42
v_and_b32 v43, 0xffff0000, v43
v_mul_f32 v24, v40, v22
v_mul_f32 v25, v41, v22
v_mul_f32 v26, v42, v22
v_mul_f32 v27, v43, v22
v_fma_f32 v40, -v24, v21, v40
v_fma_f32 v41, -v25, v21, v41
v_fma_f32 v42, -v26, v21, v42
v_fma_f32 v43, -v27, v21, v43
v_fma_f32 v40, v40, v22, v24
v_fma_f32 v41, v41, v22, v25
v_fma_f32 v42, v42, v22, v26
v_fma_f32 v43, v43, v22, v27
v_cvt_pk_bf16_f32 v40, v40, v40
v_cvt_pk_bf16_f32 v41, v41, v41
v_cvt_pk_bf16_f32 v42, v42, v42
v_cvt_pk_bf16_f32 v43, v43, v43
v_and_b32 v24, 0xffff, v40
v_and_b32 v25, 0xffff, v41
v_and_b32 v26, 0xffff, v42
v_and_b32 v27, 0xffff, v43
v_and_b32 v40, 0xffff0000, v40
v_and_b32 v41, 0xffff0000, v41
v_and_b32 v42, 0xffff0000, v42
v_and_b32 v43, 0xffff0000, v43
s_waitcnt vmcnt(6)
v_dot2_f32_bf16 v32, v160, v24, 0
v_dot2_f32_bf16 v33, v160, v40, 0
v_dot2_f32_bf16 v34, v161, v24, 0
v_dot2_f32_bf16 v35, v161, v40, 0
v_dot2_f32_bf16 v36, v162, v24, 0
v_dot2_f32_bf16 v37, v162, v40, 0
v_dot2_f32_bf16 v38, v163, v24, 0
v_dot2_f32_bf16 v39, v163, v40, 0
v_dot2_f32_bf16 v32, v164, v25, v32
v_dot2_f32_bf16 v33, v164, v41, v33
v_dot2_f32_bf16 v34, v165, v25, v34
v_dot2_f32_bf16 v35, v165, v41, v35
v_dot2_f32_bf16 v36, v166, v25, v36
v_dot2_f32_bf16 v37, v166, v41, v37
v_dot2_f32_bf16 v38, v167, v25, v38
v_dot2_f32_bf16 v39, v167, v41, v39
v_dot2_f32_bf16 v32, v168, v26, v32
v_dot2_f32_bf16 v33, v168, v42, v33
v_dot2_f32_bf16 v34, v169, v26, v34
v_dot2_f32_bf16 v35, v169, v42, v35
v_dot2_f32_bf16 v36, v170, v26, v36
v_dot2_f32_bf16 v37, v170, v42, v37
v_dot2_f32_bf16 v38, v171, v26, v38
v_dot2_f32_bf16 v39, v171, v42, v39
v_dot2_f32_bf16 v32, v172, v27, v32
v_dot2_f32_bf16 v33, v172, v43, v33
v_dot2_f32_bf16 v34, v173, v27, v34
v_dot2_f32_bf16 v35, v173, v43, v35
v_dot2_f32_bf16 v36, v174, v27, v36
v_dot2_f32_bf16 v37, v174, v43, v37
v_dot2_f32_bf16 v38, v175, v27, v38
v_dot2_f32_bf16 v39, v175, v43, v39
v_permlane32_swap_b32 v32, v36
v_permlane32_swap_b32 v33, v37
v_permlane32_swap_b32 v34, v38
v_permlane32_swap_b32 v35, v39
v_add_f32 v32, v32, v36
v_add_f32 v33, v33, v37
v_add_f32 v34, v34, v38
v_add_f32 v35, v35, v39
s_nop 0
v_permlane16_swap_b32 v32, v34
v_permlane16_swap_b32 v33, v35
v_add_f32 v32, v32, v34
v_add_f32 v33, v33, v35
s_nop 0
v_add_f32_dpp v32, v32, v32 row_ror:8 row_mask:0xf bank_mask:0x3
v_add_f32_dpp v32, v33, v33 row_ror:8 row_mask:0xf bank_mask:0xc
v_lshlrev_b32 v12, 2, v0
ds_write_b32 v12, v32 offset:1024
v_lshlrev_b32 v12, 2, v1
s_waitcnt lgkmcnt(0)
s_barrier
ds_read2st64_b32 v[32:33], v12 offset0:4 offset1:5
ds_read2st64_b32 v[34:35], v12 offset0:6 offset1:7
s_add_u32 s89, s89, 0x9e3779b9
v_mov_b32 v55, s89
s_waitcnt lgkmcnt(0)
v_add_f32 v32, v32, v33
v_add_f32 v34, v34, v35
v_add_f32 v54, v32, v34
buffer_store_dwordx2 v[54:55], v10, s[48:51], s7 offen sc1
buffer_load_ushort v44, v18, s[52:55], s12 offen offset:0
buffer_load_ushort v45, v18, s[52:55], s12 offen offset:16
buffer_load_dwordx4 v[176:179], v47, s[60:63], s14 offen nt
buffer_load_dwordx4 v[184:187], v47, s[64:67], s14 offen nt
s_add_u32 s14, s14, 28672
buffer_load_dwordx4 v[180:183], v16, s[60:63], s14 offen nt
buffer_load_dwordx4 v[188:191], v16, s[64:67], s14 offen nt
buffer_load_dwordx4 v[88:91], v2, s[40:43], s92 offen offset:2560 nt
buffer_load_dwordx4 v[92:95], v3, s[40:43], s92 offen offset:2560 nt
buffer_load_dwordx4 v[96:99], v2, s[40:43], s92 offen offset:1024 nt
buffer_load_dwordx4 v[100:103], v3, s[40:43], s92 offen offset:1024 nt
s_memtime s[100:101]
s_waitcnt lgkmcnt(0)
s_load_dword s78, s[72:73], s74
s_waitcnt lgkmcnt(0)
s_memtime s[96:97]
s_waitcnt lgkmcnt(0)
s_sub_u32 s8, s96, s100
s_xor_b32 s74, s74, 0x2000
buffer_load_dwordx4 v[104:107], v2, s[40:43], s92 offen offset:1536 nt
buffer_load_dwordx4 v[108:111], v3, s[40:43], s92 offen offset:1536 nt
buffer_load_dwordx4 v[112:115], v2, s[40:43], s92 offen offset:3072 nt
buffer_load_dwordx4 v[116:119], v3, s[40:43], s92 offen offset:3072 nt
s_memtime s[100:101]
s_waitcnt lgkmcnt(0)
s_load_dword s78, s[72:73], s74
s_waitcnt lgkmcnt(0)
s_memtime s[96:97]
s_waitcnt lgkmcnt(0)
s_sub_u32 s9, s96, s100
s_sub_i32 s8, s8, s9
s_sub_i32 s9, 0, s8
s_cmp_eq_u32 s76, 0
s_cselect_b32 s8, s8, s9
s_max_i32 s8, s8, -2047
s_min_i32 s8, s8, 2047
s_add_i32 s8, s8, 2048
s_lshr_b32 s9, s3, 1
s_mul_i32 s9, s9, 13
s_lshl_b32 s8, s8, s9
s_or_b32 s8, s8, 0x20000000
v_mov_b32 v12, s8
v_mov_b32 v13, 0
s_mov_b64 exec, 1
ds_add_rtn_u32 v13, v13, v12 offset:544
s_mov_b64 exec, -1
s_lshl_b32 s10, s79, 4
s_andn2_b32 s9, s89, 63
s_or_b32 s10, s10, s9
s_lshl_b32 s9, s2, 2
s_add_u32 s9, s9, 3014656
s_waitcnt lgkmcnt(0)
v_readfirstlane_b32 s72, v13
s_nop 0
s_add_u32 s72, s72, s8
s_bitcmp0_b32 s72, 31
s_cbranch_scc1 novote
s_and_b32 s73, s72, 0x1fff
s_cmp_gt_u32 s73, 4096
s_cselect_b32 s73, 1, 0
s_or_b32 s10, s10, s73
s_bfe_u32 s73, s72, 0xd000d
s_cmp_gt_u32 s73, 4096
s_cselect_b32 s73, 2, 0
s_or_b32 s10, s10, s73
v_mov_b32 v12, s10
buffer_store_dword v12, v19, s[48:51], s9 offen sc1
novote:
v_lshlrev_b32 v18, 3, v1
buffer_load_dwordx2 v[32:33], v18, s[48:51], s15 offen offset:0 sc1
buffer_load_dwordx2 v[34:35], v18, s[48:51], s15 offen offset:2048 sc1
s_add_u32 s9, s15, 4096
buffer_load_dwordx2 v[36:37], v18, s[48:51], s9 offen offset:0 sc1
buffer_load_dwordx2 v[38:39], v18, s[48:51], s9 offen offset:2048 sc1
buffer_load_dwordx4 v[120:123], v2, s[40:43], s92 offen offset:3584 nt
buffer_load_dwordx4 v[124:127], v3, s[40:43], s92 offen offset:3584 nt
s_xor_b32 s92, s90, 0x202000
buffer_load_dwordx4 v[128:131], v2, s[40:43], s92 offen offset:0 nt
buffer_load_dwordx4 v[132:135], v3, s[40:43], s92 offen offset:0 nt
buffer_load_dwordx4 v[136:139], v2, s[40:43], s92 offen offset:512 nt
buffer_load_dwordx4 v[140:143], v3, s[40:43], s92 offen offset:512 nt
buffer_load_dwordx4 v[144:147], v2, s[40:43], s92 offen offset:2048 nt
buffer_load_dwordx4 v[148:151], v3, s[40:43], s92 offen offset:2048 nt
buffer_load_dwordx4 v[152:155], v2, s[40:43], s92 offen offset:2560 nt
buffer_load_dwordx4 v[156:159], v3, s[40:43], s92 offen offset:2560 nt
v_lshlrev_b32 v9, 2, v1
v_add_u32 v9, 5120, v9
s_lshl_b32 s8, s3, 7
s_add_u32 s9, s8, 5120
v_and_b32 v8, 15, v1
v_lshl_add_u32 v8, v8, 2, s9
s_mov_b32 s97, s2
s_xor_b32 s7, s2, 4
v_cmp_gt_u32 vcc, 32, v1
s_nop 1
v_cndmask_b32 v53, 0, 16, vcc
s_mov_b32 s84, 0xcccccccc
s_mov_b32 s85, 0xcccccccc
s_mov_b32 s86, 0xaaaaaaaa
s_mov_b32 s87, 0xaaaaaaaa
s_mov_b32 s88, 0x3db8aa3b
s_mov_b32 s77, 0x100000
v_lshrrev_b32 v56, 5, v1
v_lshlrev_b32 v56, 14, v56
v_bfe_u32 v12, v1, 1, 3
v_lshlrev_b32 v12, 11, v12
v_add_u32 v56, v56, v12
v_and_b32 v12, 1, v1
v_lshlrev_b32 v12, 5, v12
v_add_u32 v56, v56, v12
v_and_b32 v12, 16, v1
v_add_u32 v56, v56, v12
v_lshlrev_b32 v12, 11, v1
v_cmp_gt_u32 vcc, 16, v1
s_nop 1
v_cndmask_b32 v57, v15, v12, vcc
v_and_b32 v12, 15, v1
v_lshrrev_b32 v13, 4, v1
v_lshl_add_u32 v12, v12, 1, v13
v_mul_u32_u24 v12, 4352, v12
v_mov_b32 v13, 0x80000000
v_cmp_gt_u32 vcc, 32, v1
s_nop 1
v_cndmask_b32 v58, v13, v12, vcc
v_and_b32 v12, 8, v1
v_cmp_eq_u32 vcc, 0, v12
s_nop 1
v_cndmask_b32 v59, v13, v58, vcc
s_lshl_b32 s80, s5, 15
s_lshl_b32 s10, s6, 7
s_add_u32 s80, s80, s10
s_add_u32 s80, s80, 2097152
s_add_u32 s81, s80, 64
s_lshl_b32 s82, s2, 4
s_add_u32 s82, s82, 1572864
s_lshl_b32 s14, s11, 13
s_lshl_b32 s10, s13, 6
s_add_u32 s14, s14, s10
s_lshl_b32 s10, s3, 9
s_add_u32 s14, s14, s10
s_add_u32 s14, s14, 3145216
s_cmp_lt_u32 s11, 28
s_cselect_b32 s10, 0, 0x80000000
s_add_u32 s9, s3, 3
s_bitcmp1_b32 s9, 1
s_cselect_b32 s10, 0x80000000, s10
v_or_b32 v46, s10, v46
s_and_b32 s12, s11, 7
s_mul_i32 s12, s12, 4352
s_add_u32 s12, s12, 3014656
s_waitcnt vmcnt(26)
v_lshlrev_b32 v44, 16, v44
v_lshlrev_b32 v45, 16, v45
v_sub_f32 v44, v44, v20
v_sub_f32 v45, v45, v20
v_cvt_pk_bf16_f32 v44, v44, v44
v_cvt_pk_bf16_f32 v45, v45, v45
v_and_b32 v44, 0xffff0000, v44
v_and_b32 v45, 0xffff0000, v45
v_mul_f32 v12, v44, v22
v_mul_f32 v13, v45, v22
v_fma_f32 v44, -v12, v21, v44
v_fma_f32 v45, -v13, v21, v45
v_fma_f32 v44, v44, v22, v12
v_fma_f32 v45, v45, v22, v13
v_cvt_pk_bf16_f32 v44, v44, v44
v_cvt_pk_bf16_f32 v45, v45, v45
v_and_b32 v12, 0xffff, v44
v_and_b32 v13, 0xffff, v45
v_and_b32 v44, 0xffff0000, v44
v_and_b32 v45, 0xffff0000, v45
s_waitcnt vmcnt(22)
v_dot2_f32_bf16 v24, v176, v12, 0
v_dot2_f32_bf16 v25, v176, v44, 0
v_dot2_f32_bf16 v26, v177, v12, 0
v_dot2_f32_bf16 v27, v177, v44, 0
v_dot2_f32_bf16 v28, v178, v12, 0
v_dot2_f32_bf16 v29, v178, v44, 0
v_dot2_f32_bf16 v30, v179, v12, 0
v_dot2_f32_bf16 v31, v179, v44, 0
v_dot2_f32_bf16 v192, v184, v12, 0
v_dot2_f32_bf16 v193, v184, v44, 0
v_dot2_f32_bf16 v194, v185, v12, 0
v_dot2_f32_bf16 v195, v185, v44, 0
v_dot2_f32_bf16 v196, v186, v12, 0
v_dot2_f32_bf16 v197, v186, v44, 0
v_dot2_f32_bf16 v198, v187, v12, 0
v_dot2_f32_bf16 v199, v187, v44, 0
v_dot2_f32_bf16 v24, v180, v13, v24
v_dot2_f32_bf16 v25, v180, v45, v25
v_dot2_f32_bf16 v26, v181, v13, v26
v_dot2_f32_bf16 v27, v181, v45, v27
v_dot2_f32_bf16 v28, v182, v13, v28
v_dot2_f32_bf16 v29, v182, v45, v29
v_dot2_f32_bf16 v30, v183, v13, v30
v_dot2_f32_bf16 v31, v183, v45, v31
v_dot2_f32_bf16 v192, v188, v13, v192
v_dot2_f32_bf16 v193, v188, v45, v193
v_dot2_f32_bf16 v194, v189, v13, v194
v_dot2_f32_bf16 v195, v189, v45, v195
v_dot2_f32_bf16 v196, v190, v13, v196
v_dot2_f32_bf16 v197, v190, v45, v197
v_dot2_f32_bf16 v198, v191, v13, v198
v_dot2_f32_bf16 v199, v191, v45, v199
v_permlane32_swap_b32 v24, v28
v_permlane32_swap_b32 v25, v29
v_permlane32_swap_b32 v26, v30
v_permlane32_swap_b32 v27, v31
v_add_f32 v24, v24, v28
v_add_f32 v25, v25, v29
v_add_f32 v26, v26, v30
v_add_f32 v27, v27, v31
s_nop 0
v_permlane16_swap_b32 v24, v26
v_permlane16_swap_b32 v25, v27
v_add_f32 v24, v24, v26
v_add_f32 v25, v25, v27
s_nop 0
v_add_f32_dpp v24, v24, v24 row_ror:8 row_mask:0xf bank_mask:0x3
v_add_f32_dpp v24, v25, v25 row_ror:8 row_mask:0xf bank_mask:0xc
v_permlane32_swap_b32 v192, v196
v_permlane32_swap_b32 v193, v197
v_permlane32_swap_b32 v194, v198
v_permlane32_swap_b32 v195, v199
v_add_f32 v192, v192, v196
v_add_f32 v193, v193, v197
v_add_f32 v194, v194, v198
v_add_f32 v195, v195, v199
s_nop 0
v_permlane16_swap_b32 v192, v194
v_permlane16_swap_b32 v193, v195
v_add_f32 v192, v192, v194
v_add_f32 v193, v193, v195
s_nop 0
v_add_f32_dpp v192, v192, v192 row_ror:8 row_mask:0xf bank_mask:0x3
v_add_f32_dpp v192, v193, v193 row_ror:8 row_mask:0xf bank_mask:0xc
v_lshlrev_b32 v12, 2, v0
ds_write_b32 v12, v24 offset:2048
ds_write_b32 v12, v192 offset:3072
v_lshrrev_b32 v14, 1, v1
v_xor_b32 v14, v14, v1
v_and_b32 v14, 8, v14
v_bfe_u32 v15, v1, 1, 2
v_or_b32 v14, v14, v15
v_and_b32 v15, 1, v1
v_lshlrev_b32 v15, 4, v15
v_mov_b32 v20, 0xffff
v_lshlrev_b32 v15, v15, v20
v_cmp_eq_u32 vcc, 0, v14
s_nop 1
v_cndmask_b32 v20, 0, v15, vcc
v_cmp_eq_u32 vcc, 1, v14
s_nop 1
v_cndmask_b32 v21, 0, v15, vcc
v_cmp_eq_u32 vcc, 2, v14
s_nop 1
v_cndmask_b32 v22, 0, v15, vcc
v_cmp_eq_u32 vcc, 3, v14
s_nop 1
v_cndmask_b32 v23, 0, v15, vcc
s_mov_b32 s78, 0
s_waitcnt vmcnt(10)
v_xor_b32 v40, s89, v33
v_xor_b32 v41, s89, v35
v_xor_b32 v42, s89, v37
v_xor_b32 v43, s89, v39
v_or3_b32 v40, v40, v41, v42
v_or_b32 v40, v40, v43
v_cmp_ne_u32 vcc, 0, v40
s_cbranch_vccz g_ok
s_mov_b32 s78, 1
buffer_load_dwordx2 v[32:33], v18, s[48:51], s15 offen offset:0 sc1
buffer_load_dwordx2 v[34:35], v18, s[48:51], s15 offen offset:2048 sc1
s_add_u32 s9, s15, 4096
buffer_load_dwordx2 v[36:37], v18, s[48:51], s9 offen offset:0 sc1
buffer_load_dwordx2 v[38:39], v18, s[48:51], s9 offen offset:2048 sc1
buffer_load_dwordx4 v[160:163], v2, s[40:43], s92 offen offset:1024 nt
buffer_load_dwordx4 v[164:167], v3, s[40:43], s92 offen offset:1024 nt
buffer_load_dwordx4 v[168:171], v2, s[40:43], s92 offen offset:1536 nt
buffer_load_dwordx4 v[172:175], v3, s[40:43], s92 offen offset:1536 nt
s_waitcnt vmcnt(4)
v_xor_b32 v40, s89, v33
v_xor_b32 v41, s89, v35
v_xor_b32 v42, s89, v37
v_xor_b32 v43, s89, v39
v_or3_b32 v40, v40, v41, v42
v_or_b32 v40, v40, v43
v_cmp_ne_u32 vcc, 0, v40
s_cbranch_vccz g_ok
s_mov_b32 s78, 2
buffer_load_dwordx2 v[32:33], v18, s[48:51], s15 offen offset:0 sc1
buffer_load_dwordx2 v[34:35], v18, s[48:51], s15 offen offset:2048 sc1
s_add_u32 s9, s15, 4096
buffer_load_dwordx2 v[36:37], v18, s[48:51], s9 offen offset:0 sc1
buffer_load_dwordx2 v[38:39], v18, s[48:51], s9 offen offset:2048 sc1
buffer_load_dwordx4 v[176:179], v2, s[40:43], s92 offen offset:3072 nt
buffer_load_dwordx4 v[180:183], v3, s[40:43], s92 offen offset:3072 nt
buffer_load_dwordx4 v[184:187], v2, s[40:43], s92 offen offset:3584 nt
buffer_load_dwordx4 v[188:191], v3, s[40:43], s92 offen offset:3584 nt
s_mov_b32 s96, 200000
s_waitcnt vmcnt(4)
g_spin:
v_xor_b32 v40, s89, v33
v_xor_b32 v41, s89, v35
v_xor_b32 v42, s89, v37
v_xor_b32 v43, s89, v39
v_or3_b32 v40, v40, v41, v42
v_or_b32 v40, v40, v43
v_cmp_ne_u32 vcc, 0, v40
s_cbranch_vccz g_ok
s_sub_u32 s96, s96, 1
s_cmp_eq_u32 s96, 0
s_cbranch_scc1 g_ok
s_sleep 8
buffer_load_dwordx2 v[32:33], v18, s[48:51], s15 offen offset:0 sc1
buffer_load_dwordx2 v[34:35], v18, s[48:51], s15 offen offset:2048 sc1
s_add_u32 s9, s15, 4096
buffer_load_dwordx2 v[36:37], v18, s[48:51], s9 offen offset:0 sc1
buffer_load_dwordx2 v[38:39], v18, s[48:51], s9 offen offset:2048 sc1
s_waitcnt vmcnt(0)
s_branch g_spin
g_ok:
v_add_f32 v32, v32, v34
v_add_f32 v36, v36, v38
v_add_f32 v32, v32, v36
v_cvt_pk_bf16_f32 v32, v32, v32
v_lshlrev_b32 v33, 1, v0
ds_write_b16 v33, v32
v_and_b32 v34, 31, v1
v_lshlrev_b32 v34, 4, v34
s_max_u32 s8, s3, 1
s_min_u32 s8, s8, 2
s_lshl_b32 s8, s8, 10
v_lshl_add_u32 v35, v1, 2, s8
s_waitcnt lgkmcnt(0)
s_barrier
ds_read_b128 v[4:7], v34
ds_read2st64_b32 v[40:41], v35 offset0:4 offset1:5
ds_read2st64_b32 v[42:43], v35 offset0:6 offset1:7
s_cmp_eq_u32 s78, 2
s_cbranch_scc1 g_p2
s_cmp_eq_u32 s78, 1
s_cbranch_scc1 g_p1
buffer_load_dwordx4 v[160:163], v2, s[40:43], s92 offen offset:1024 nt
buffer_load_dwordx4 v[164:167], v3, s[40:43], s92 offen offset:1024 nt
buffer_load_dwordx4 v[168:171], v2, s[40:43], s92 offen offset:1536 nt
buffer_load_dwordx4 v[172:175], v3, s[40:43], s92 offen offset:1536 nt
g_p1:
buffer_load_dwordx4 v[176:179], v2, s[40:43], s92 offen offset:3072 nt
buffer_load_dwordx4 v[180:183], v3, s[40:43], s92 offen offset:3072 nt
buffer_load_dwordx4 v[184:187], v2, s[40:43], s92 offen offset:3584 nt
buffer_load_dwordx4 v[188:191], v3, s[40:43], s92 offen offset:3584 nt
g_p2:
s_waitcnt lgkmcnt(0)
v_add_f32 v40, v40, v41
v_add_f32 v42, v42, v43
v_add_f32 v54, v40, v42
buffer_store_dwordx2 v[54:55], v46, s[48:51], s14 offen sc1
v_mov_b32 v52, 0xff800000
v_mov_b32 v12, 0
v_mov_b32 v48, 0
v_mov_b32 v49, 0
v_mov_b32 v50, 0
v_mov_b32 v51, 0
s_cmp_eq_u32 s3, 0
s_cbranch_scc1 streamer
v_dot2_f32_bf16 v32, v64, v4, 0
v_dot2_f32_bf16 v33, v68, v4, 0
v_dot2_f32_bf16 v32, v65, v5, v32
v_dot2_f32_bf16 v33, v69, v5, v33
v_dot2_f32_bf16 v32, v66, v6, v32
v_dot2_f32_bf16 v33, v70, v6, v33
v_dot2_f32_bf16 v32, v67, v7, v32
v_dot2_f32_bf16 v33, v71, v7, v33
v_dot2_f32_bf16 v34, v72, v4, 0
v_dot2_f32_bf16 v35, v76, v4, 0
v_dot2_f32_bf16 v34, v73, v5, v34
v_dot2_f32_bf16 v35, v77, v5, v35
v_dot2_f32_bf16 v34, v74, v6, v34
v_dot2_f32_bf16 v35, v78, v6, v35
v_dot2_f32_bf16 v34, v75, v7, v34
v_dot2_f32_bf16 v35, v79, v7, v35
v_dot2_f32_bf16 v36, v80, v4, 0
v_dot2_f32_bf16 v37, v84, v4, 0
v_dot2_f32_bf16 v36, v81, v5, v36
v_dot2_f32_bf16 v37, v85, v5, v37
v_dot2_f32_bf16 v36, v82, v6, v36
v_dot2_f32_bf16 v37, v86, v6, v37
v_dot2_f32_bf16 v36, v83, v7, v36
v_dot2_f32_bf16 v37, v87, v7, v37
v_dot2_f32_bf16 v38, v88, v4, 0
v_dot2_f32_bf16 v39, v92, v4, 0
v_dot2_f32_bf16 v38, v89, v5, v38
v_dot2_f32_bf16 v39, v93, v5, v39
v_dot2_f32_bf16 v38, v90, v6, v38
v_dot2_f32_bf16 v39, v94, v6, v39
v_dot2_f32_bf16 v38, v91, v7, v38
v_dot2_f32_bf16 v39, v95, v7, v39
v_dot2_f32_bf16 v40, v96, v4, 0
v_dot2_f32_bf16 v41, v100, v4, 0
v_dot2_f32_bf16 v40, v97, v5, v40
v_dot2_f32_bf16 v41, v101, v5, v41
v_dot2_f32_bf16 v40, v98, v6, v40
v_dot2_f32_bf16 v41, v102, v6, v41
v_dot2_f32_bf16 v40, v99, v7, v40
v_dot2_f32_bf16 v41, v103, v7, v41
v_dot2_f32_bf16 v42, v104, v4, 0
v_dot2_f32_bf16 v43, v108, v4, 0
v_dot2_f32_bf16 v42, v105, v5, v42
v_dot2_f32_bf16 v43, v109, v5, v43
v_dot2_f32_bf16 v42, v106, v6, v42
v_dot2_f32_bf16 v43, v110, v6, v43
v_dot2_f32_bf16 v42, v107, v7, v42
v_dot2_f32_bf16 v43, v111, v7, v43
v_dot2_f32_bf16 v44, v112, v4, 0
v_dot2_f32_bf16 v45, v116, v4, 0
v_dot2_f32_bf16 v44, v113, v5, v44
v_dot2_f32_bf16 v45, v117, v5, v45
v_dot2_f32_bf16 v44, v114, v6, v44
v_dot2_f32_bf16 v45, v118, v6, v45
v_dot2_f32_bf16 v44, v115, v7, v44
v_dot2_f32_bf16 v45, v119, v7, v45
s_waitcnt vmcnt(17)
v_dot2_f32_bf16 v46, v120, v4, 0
v_dot2_f32_bf16 v47, v124, v4, 0
v_dot2_f32_bf16 v46, v121, v5, v46
v_dot2_f32_bf16 v47, v125, v5, v47
v_dot2_f32_bf16 v46, v122, v6, v46
v_dot2_f32_bf16 v47, v126, v6, v47
v_dot2_f32_bf16 v46, v123, v7, v46
v_dot2_f32_bf16 v47, v127, v7, v47
v_add_f32_dpp v32, v32, v32 row_ror:8 row_mask:0xf bank_mask:0x3
v_add_f32_dpp v33, v33, v33 row_ror:8 row_mask:0xf bank_mask:0x3
v_add_f32_dpp v34, v34, v34 row_ror:8 row_mask:0xf bank_mask:0x3
v_add_f32_dpp v35, v35, v35 row_ror:8 row_mask:0xf bank_mask:0x3
v_add_f32_dpp v36, v36, v36 row_ror:8 row_mask:0xf bank_mask:0x3
v_add_f32_dpp v37, v37, v37 row_ror:8 row_mask:0xf bank_mask:0x3
v_add_f32_dpp v38, v38, v38 row_ror:8 row_mask:0xf bank_mask:0x3
v_add_f32_dpp v39, v39, v39 row_ror:8 row_mask:0xf bank_mask:0x3
v_add_f32_dpp v32, v40, v40 row_ror:8 row_mask:0xf bank_mask:0xc
v_add_f32_dpp v33, v41, v41 row_ror:8 row_mask:0xf bank_mask:0xc
v_add_f32_dpp v34, v42, v42 row_ror:8 row_mask:0xf bank_mask:0xc
v_add_f32_dpp v35, v43, v43 row_ror:8 row_mask:0xf bank_mask:0xc
v_add_f32_dpp v36, v44, v44 row_ror:8 row_mask:0xf bank_mask:0xc
v_add_f32_dpp v37, v45, v45 row_ror:8 row_mask:0xf bank_mask:0xc
v_add_f32_dpp v38, v46, v46 row_ror:8 row_mask:0xf bank_mask:0xc
v_add_f32_dpp v39, v47, v47 row_ror:8 row_mask:0xf bank_mask:0xc
v_add_f32_dpp v32, v32, v32 row_shl:4 row_mask:0xf bank_mask:0x5
v_add_f32_dpp v33, v33, v33 row_shl:4 row_mask:0xf bank_mask:0x5
v_add_f32_dpp v34, v34, v34 row_shl:4 row_mask:0xf bank_mask:0x5
v_add_f32_dpp v35, v35, v35 row_shl:4 row_mask:0xf bank_mask:0x5
v_add_f32_dpp v32, v36, v36 row_shr:4 row_mask:0xf bank_mask:0xa
v_add_f32_dpp v33, v37, v37 row_shr:4 row_mask:0xf bank_mask:0xa
v_add_f32_dpp v34, v38, v38 row_shr:4 row_mask:0xf bank_mask:0xa
v_add_f32_dpp v35, v39, v39 row_shr:4 row_mask:0xf bank_mask:0xa
v_add_f32_dpp v32, v32, v32 quad_perm:[2,3,0,1] row_mask:0xf bank_mask:0xf
v_add_f32_dpp v33, v33, v33 quad_perm:[2,3,0,1] row_mask:0xf bank_mask:0xf
v_add_f32_dpp v34, v34, v34 quad_perm:[2,3,0,1] row_mask:0xf bank_mask:0xf
v_add_f32_dpp v35, v35, v35 quad_perm:[2,3,0,1] row_mask:0xf bank_mask:0xf
v_cndmask_b32 v32, v32, v34, s[84:85]
v_cndmask_b32 v33, v33, v35, s[84:85]
s_nop 0
v_add_f32_dpp v32, v32, v32 quad_perm:[1,0,3,2] row_mask:0xf bank_mask:0xf
v_add_f32_dpp v33, v33, v33 quad_perm:[1,0,3,2] row_mask:0xf bank_mask:0xf
v_cndmask_b32 v32, v32, v33, s[86:87]
v_mov_b32 v33, v32
s_nop 1
v_permlane16_swap_b32 v32, v33
v_add_f32 v32, v32, v33
v_mov_b32 v33, v32
s_nop 1
v_permlane32_swap_b32 v32, v33
v_cvt_pk_bf16_f32 v54, v32, v33
ds_write_b32 v8, v54
v_add_u32 v8, 64, v8
s_waitcnt vmcnt(15)
v_dot2_f32_bf16 v32, v128, v4, 0
v_dot2_f32_bf16 v33, v132, v4, 0
v_dot2_f32_bf16 v32, v129, v5, v32
v_dot2_f32_bf16 v33, v133, v5, v33
v_dot2_f32_bf16 v32, v130, v6, v32
v_dot2_f32_bf16 v33, v134, v6, v33
v_dot2_f32_bf16 v32, v131, v7, v32
v_dot2_f32_bf16 v33, v135, v7, v33
s_waitcnt vmcnt(13)
v_dot2_f32_bf16 v34, v136, v4, 0
v_dot2_f32_bf16 v35, v140, v4, 0
v_dot2_f32_bf16 v34, v137, v5, v34
v_dot2_f32_bf16 v35, v141, v5, v35
v_dot2_f32_bf16 v34, v138, v6, v34
v_dot2_f32_bf16 v35, v142, v6, v35
v_dot2_f32_bf16 v34, v139, v7, v34
v_dot2_f32_bf16 v35, v143, v7, v35
s_waitcnt vmcnt(11)
v_dot2_f32_bf16 v36, v144, v4, 0
v_dot2_f32_bf16 v37, v148, v4, 0
v_dot2_f32_bf16 v36, v145, v5, v36
v_dot2_f32_bf16 v37, v149, v5, v37
v_dot2_f32_bf16 v36, v146, v6, v36
v_dot2_f32_bf16 v37, v150, v6, v37
v_dot2_f32_bf16 v36, v147, v7, v36
v_dot2_f32_bf16 v37, v151, v7, v37
s_waitcnt vmcnt(9)
v_dot2_f32_bf16 v38, v152, v4, 0
v_dot2_f32_bf16 v39, v156, v4, 0
v_dot2_f32_bf16 v38, v153, v5, v38
v_dot2_f32_bf16 v39, v157, v5, v39
v_dot2_f32_bf16 v38, v154, v6, v38
v_dot2_f32_bf16 v39, v158, v6, v39
v_dot2_f32_bf16 v38, v155, v7, v38
v_dot2_f32_bf16 v39, v159, v7, v39
s_waitcnt vmcnt(7)
v_dot2_f32_bf16 v40, v160, v4, 0
v_dot2_f32_bf16 v41, v164, v4, 0
v_dot2_f32_bf16 v40, v161, v5, v40
v_dot2_f32_bf16 v41, v165, v5, v41
v_dot2_f32_bf16 v40, v162, v6, v40
v_dot2_f32_bf16 v41, v166, v6, v41
v_dot2_f32_bf16 v40, v163, v7, v40
v_dot2_f32_bf16 v41, v167, v7, v41
s_waitcnt vmcnt(5)
v_dot2_f32_bf16 v42, v168, v4, 0
v_dot2_f32_bf16 v43, v172, v4, 0
v_dot2_f32_bf16 v42, v169, v5, v42
v_dot2_f32_bf16 v43, v173, v5, v43
v_dot2_f32_bf16 v42, v170, v6, v42
v_dot2_f32_bf16 v43, v174, v6, v43
v_dot2_f32_bf16 v42, v171, v7, v42
v_dot2_f32_bf16 v43, v175, v7, v43
s_waitcnt vmcnt(3)
v_dot2_f32_bf16 v44, v176, v4, 0
v_dot2_f32_bf16 v45, v180, v4, 0
v_dot2_f32_bf16 v44, v177, v5, v44
v_dot2_f32_bf16 v45, v181, v5, v45
v_dot2_f32_bf16 v44, v178, v6, v44
v_dot2_f32_bf16 v45, v182, v6, v45
v_dot2_f32_bf16 v44, v179, v7, v44
v_dot2_f32_bf16 v45, v183, v7, v45
s_waitcnt vmcnt(1)
v_dot2_f32_bf16 v46, v184, v4, 0
v_dot2_f32_bf16 v47, v188, v4, 0
v_dot2_f32_bf16 v46, v185, v5, v46
v_dot2_f32_bf16 v47, v189, v5, v47
v_dot2_f32_bf16 v46, v186, v6, v46
v_dot2_f32_bf16 v47, v190, v6, v47
v_dot2_f32_bf16 v46, v187, v7, v46
v_dot2_f32_bf16 v47, v191, v7, v47
v_add_f32_dpp v32, v32, v32 row_ror:8 row_mask:0xf bank_mask:0x3
v_add_f32_dpp v33, v33, v33 row_ror:8 row_mask:0xf bank_mask:0x3
v_add_f32_dpp v34, v34, v34 row_ror:8 row_mask:0xf bank_mask:0x3
v_add_f32_dpp v35, v35, v35 row_ror:8 row_mask:0xf bank_mask:0x3
v_add_f32_dpp v36, v36, v36 row_ror:8 row_mask:0xf bank_mask:0x3
v_add_f32_dpp v37, v37, v37 row_ror:8 row_mask:0xf bank_mask:0x3
v_add_f32_dpp v38, v38, v38 row_ror:8 row_mask:0xf bank_mask:0x3
v_add_f32_dpp v39, v39, v39 row_ror:8 row_mask:0xf bank_mask:0x3
v_add_f32_dpp v32, v40, v40 row_ror:8 row_mask:0xf bank_mask:0xc
v_add_f32_dpp v33, v41, v41 row_ror:8 row_mask:0xf bank_mask:0xc
v_add_f32_dpp v34, v42, v42 row_ror:8 row_mask:0xf bank_mask:0xc
v_add_f32_dpp v35, v43, v43 row_ror:8 row_mask:0xf bank_mask:0xc
v_add_f32_dpp v36, v44, v44 row_ror:8 row_mask:0xf bank_mask:0xc
v_add_f32_dpp v37, v45, v45 row_ror:8 row_mask:0xf bank_mask:0xc
v_add_f32_dpp v38, v46, v46 row_ror:8 row_mask:0xf bank_mask:0xc
v_add_f32_dpp v39, v47, v47 row_ror:8 row_mask:0xf bank_mask:0xc
v_add_f32_dpp v32, v32, v32 row_shl:4 row_mask:0xf bank_mask:0x5
v_add_f32_dpp v33, v33, v33 row_shl:4 row_mask:0xf bank_mask:0x5
v_add_f32_dpp v34, v34, v34 row_shl:4 row_mask:0xf bank_mask:0x5
v_add_f32_dpp v35, v35, v35 row_shl:4 row_mask:0xf bank_mask:0x5
v_add_f32_dpp v32, v36, v36 row_shr:4 row_mask:0xf bank_mask:0xa
v_add_f32_dpp v33, v37, v37 row_shr:4 row_mask:0xf bank_mask:0xa
v_add_f32_dpp v34, v38, v38 row_shr:4 row_mask:0xf bank_mask:0xa
v_add_f32_dpp v35, v39, v39 row_shr:4 row_mask:0xf bank_mask:0xa
v_add_f32_dpp v32, v32, v32 quad_perm:[2,3,0,1] row_mask:0xf bank_mask:0xf
v_add_f32_dpp v33, v33, v33 quad_perm:[2,3,0,1] row_mask:0xf bank_mask:0xf
v_add_f32_dpp v34, v34, v34 quad_perm:[2,3,0,1] row_mask:0xf bank_mask:0xf
v_add_f32_dpp v35, v35, v35 quad_perm:[2,3,0,1] row_mask:0xf bank_mask:0xf
v_cndmask_b32 v32, v32, v34, s[84:85]
v_cndmask_b32 v33, v33, v35, s[84:85]
s_nop 0
v_add_f32_dpp v32, v32, v32 quad_perm:[1,0,3,2] row_mask:0xf bank_mask:0xf
v_add_f32_dpp v33, v33, v33 quad_perm:[1,0,3,2] row_mask:0xf bank_mask:0xf
v_cndmask_b32 v32, v32, v33, s[86:87]
v_mov_b32 v33, v32
s_nop 1
v_permlane16_swap_b32 v32, v33
v_add_f32 v32, v32, v33
v_mov_b32 v33, v32
s_nop 1
v_permlane32_swap_b32 v32, v33
v_cvt_pk_bf16_f32 v54, v32, v33
ds_write_b32 v8, v54
v_add_u32 v8, 64, v8
s_waitcnt lgkmcnt(0)
s_barrier
s_cmp_lg_u32 s3, 1
s_cbranch_scc1 main_fin
v_mov_b32 v14, 0
s_barrier
ds_read_b96 v[32:34], v14 offset:560
s_waitcnt lgkmcnt(0)
v_readfirstlane_b32 s91, v32
v_readfirstlane_b32 s93, v33
v_readfirstlane_b32 s6, v34
s_bitcmp0_b32 s93, 13
s_cbranch_scc1 x_nop
ds_read2st64_b32 v[24:25], v9 offset0:0 offset1:1
ds_read_b32 v26, v9 offset:512
v_mov_b32 v27, s89
s_lshl_b32 s8, s2, 10
s_waitcnt lgkmcnt(0)
buffer_store_dwordx4 v[24:27], v17, s[48:51], s8 offen sc1
s_lshl_b32 s8, s6, 10
buffer_load_dwordx4 v[60:63], v17, s[48:51], s8 offen sc1
s_waitcnt vmcnt(0)
s_mov_b32 s96, 200000
x_chk_p:
v_cmp_ne_u32 vcc, s89, v63
s_cbranch_vccz x_ok_p
s_sub_u32 s96, s96, 1
s_cmp_eq_u32 s96, 0
s_cbranch_scc1 x_ok_p
s_sleep 32
s_lshl_b32 s8, s6, 10
buffer_load_dwordx4 v[60:63], v17, s[48:51], s8 offen sc1
s_waitcnt vmcnt(0)
s_branch x_chk_p
x_ok_p:
ds_write2st64_b32 v9, v60, v61 offset0:0 offset1:1
ds_write_b32 v9, v62 offset:512
s_waitcnt lgkmcnt(0)
x_nop:
s_barrier
s_bitcmp0_b32 s93, 14
s_cbranch_scc1 x_nor
ds_read2st64_b32 v[32:33], v9 offset0:3 offset1:4
ds_read_b32 v34, v9 offset:1280
v_mov_b32 v35, s89
ds_read2st64_b32 v[36:37], v9 offset0:6 offset1:7
ds_read_b32 v38, v9 offset:2048
v_mov_b32 v39, s89
ds_read2st64_b32 v[40:41], v9 offset0:9 offset1:10
ds_read_b32 v42, v9 offset:2816
v_mov_b32 v43, s89
ds_read2st64_b32 v[44:45], v9 offset0:12 offset1:13
ds_read_b32 v46, v9 offset:3584
v_mov_b32 v47, s89
ds_read_b32 v60, v9 offset:3840
v_mov_b32 v61, s89
v_lshlrev_b32 v11, 3, v1
s_waitcnt lgkmcnt(0)
s_mul_i32 s8, s97, 4608
s_add_u32 s8, s8, 262144
s_add_u32 s9, s8, 4096
buffer_store_dwordx4 v[32:35], v17, s[48:51], s8 offen offset:0 sc1
buffer_store_dwordx4 v[36:39], v17, s[48:51], s8 offen offset:1024 sc1
buffer_store_dwordx4 v[40:43], v17, s[48:51], s8 offen offset:2048 sc1
buffer_store_dwordx4 v[44:47], v17, s[48:51], s8 offen offset:3072 sc1
buffer_store_dwordx2 v[60:61], v11, s[48:51], s9 offen sc1
s_mul_i32 s12, s7, 4608
s_add_u32 s12, s12, 266244
v_mov_b32 v18, 0
s_mov_b64 exec, 1
buffer_load_dword v19, v18, s[48:51], s12 offen sc1
s_waitcnt vmcnt(0)
s_mov_b32 s96, 200000
x_chk_t:
v_cmp_ne_u32 vcc, s89, v19
s_cbranch_vccz x_ok_t
s_sub_u32 s96, s96, 1
s_cmp_eq_u32 s96, 0
s_cbranch_scc1 x_ok_t
s_sleep 12
buffer_load_dword v19, v18, s[48:51], s12 offen sc1
s_waitcnt vmcnt(0)
s_branch x_chk_t
x_ok_t:
s_mov_b64 exec, -1
s_mul_i32 s8, s7, 4608
s_add_u32 s8, s8, 262144
s_add_u32 s9, s8, 4096
buffer_load_dwordx4 v[32:35], v17, s[48:51], s8 offen offset:0 sc1
buffer_load_dwordx4 v[36:39], v17, s[48:51], s8 offen offset:1024 sc1
buffer_load_dwordx4 v[40:43], v17, s[48:51], s8 offen offset:2048 sc1
buffer_load_dwordx4 v[44:47], v17, s[48:51], s8 offen offset:3072 sc1
buffer_load_dwordx2 v[60:61], v11, s[48:51], s9 offen sc1
s_waitcnt vmcnt(0)
s_mov_b32 s96, 200000
x_chk_r:
v_cmp_ne_u32 vcc, s89, v35
v_cmp_ne_u32 s[10:11], s89, v39
s_nop 0
s_or_b64 vcc, vcc, s[10:11]
v_cmp_ne_u32 s[10:11], s89, v43
s_nop 0
s_or_b64 vcc, vcc, s[10:11]
v_cmp_ne_u32 s[10:11], s89, v47
s_nop 0
s_or_b64 vcc, vcc, s[10:11]
v_cmp_ne_u32 s[10:11], s89, v61
s_nop 0
s_or_b64 vcc, vcc, s[10:11]
s_cbranch_vccz x_ok_r
s_sub_u32 s96, s96, 1
s_cmp_eq_u32 s96, 0
s_cbranch_scc1 x_ok_r
s_sleep 4
s_mul_i32 s8, s7, 4608
s_add_u32 s8, s8, 262144
s_add_u32 s9, s8, 4096
buffer_load_dwordx4 v[32:35], v17, s[48:51], s8 offen offset:0 sc1
buffer_load_dwordx4 v[36:39], v17, s[48:51], s8 offen offset:1024 sc1
buffer_load_dwordx4 v[40:43], v17, s[48:51], s8 offen offset:2048 sc1
buffer_load_dwordx4 v[44:47], v17, s[48:51], s8 offen offset:3072 sc1
buffer_load_dwordx2 v[60:61], v11, s[48:51], s9 offen sc1
s_waitcnt vmcnt(0)
s_branch x_chk_r
x_ok_r:
ds_write2st64_b32 v9, v32, v33 offset0:3 offset1:4
ds_write_b32 v9, v34 offset:1280
ds_write2st64_b32 v9, v36, v37 offset0:6 offset1:7
ds_write_b32 v9, v38 offset:2048
ds_write2st64_b32 v9, v40, v41 offset0:9 offset1:10
ds_write_b32 v9, v42 offset:2816
ds_write2st64_b32 v9, v44, v45 offset0:12 offset1:13
ds_write_b32 v9, v46 offset:3584
ds_write_b32 v9, v60 offset:3840
s_waitcnt lgkmcnt(0)
x_nor:
s_barrier
s_barrier
v_add_u32 v8, 3392, v8
s_mov_b32 s13, 2
s_mov_b32 s15, 128
s_mov_b32 s14, 128
s_mov_b32 s94, 61
s_xor_b32 s92, s91, 0x363000
buffer_load_dwordx4 v[64:67], v2, s[44:47], s92 offen offset:0 nt
buffer_load_dwordx4 v[68:71], v3, s[44:47], s92 offen offset:0 nt
buffer_load_dwordx4 v[72:75], v2, s[44:47], s92 offen offset:512 nt
buffer_load_dwordx4 v[76:79], v3, s[44:47], s92 offen offset:512 nt
buffer_load_dwordx4 v[80:83], v2, s[44:47], s92 offen offset:2048 nt
buffer_load_dwordx4 v[84:87], v3, s[44:47], s92 offen offset:2048 nt
buffer_load_dwordx4 v[88:91], v2, s[44:47], s92 offen offset:2560 nt
buffer_load_dwordx4 v[92:95], v3, s[44:47], s92 offen offset:2560 nt
buffer_load_dwordx4 v[96:99], v2, s[44:47], s92 offen offset:1024 nt
buffer_load_dwordx4 v[100:103], v3, s[44:47], s92 offen offset:1024 nt
buffer_load_dwordx4 v[104:107], v2, s[44:47], s92 offen offset:1536 nt
buffer_load_dwordx4 v[108:111], v3, s[44:47], s92 offen offset:1536 nt
buffer_load_dwordx4 v[112:115], v2, s[44:47], s92 offen offset:3072 nt
buffer_load_dwordx4 v[116:119], v3, s[44:47], s92 offen offset:3072 nt
buffer_load_dwordx4 v[120:123], v2, s[44:47], s92 offen offset:3584 nt
buffer_load_dwordx4 v[124:127], v3, s[44:47], s92 offen offset:3584 nt
s_xor_b32 s92, s91, 0x7e7000
buffer_load_dwordx4 v[128:131], v2, s[44:47], s92 offen offset:0 nt
buffer_load_dwordx4 v[132:135], v3, s[44:47], s92 offen offset:0 nt
buffer_load_dwordx4 v[136:139], v2, s[44:47], s92 offen offset:512 nt
buffer_load_dwordx4 v[140:143], v3, s[44:47], s92 offen offset:512 nt
buffer_load_dwordx4 v[144:147], v2, s[44:47], s92 offen offset:2048 nt
buffer_load_dwordx4 v[148:151], v3, s[44:47], s92 offen offset:2048 nt
buffer_load_dwordx4 v[152:155], v2, s[44:47], s92 offen offset:2560 nt
buffer_load_dwordx4 v[156:159], v3, s[44:47], s92 offen offset:2560 nt
buffer_load_dwordx4 v[160:163], v2, s[44:47], s92 offen offset:1024 nt
buffer_load_dwordx4 v[164:167], v3, s[44:47], s92 offen offset:1024 nt
buffer_load_dwordx4 v[168:171], v2, s[44:47], s92 offen offset:1536 nt
buffer_load_dwordx4 v[172:175], v3, s[44:47], s92 offen offset:1536 nt
buffer_load_dwordx4 v[176:179], v2, s[44:47], s92 offen offset:3072 nt
buffer_load_dwordx4 v[180:183], v3, s[44:47], s92 offen offset:3072 nt
buffer_load_dwordx4 v[184:187], v2, s[44:47], s92 offen offset:3584 nt
buffer_load_dwordx4 v[188:191], v3, s[44:47], s92 offen offset:3584 nt
ds_read_b32 v10, v8
v_add_u32 v8, s14, v8
s_waitcnt lgkmcnt(0)
v_lshlrev_b32 v16, v53, v10
v_and_b32 v16, 0xffff0000, v16
s_nop 1
v_max_f32_dpp v14, v16, v16 row_ror:8 row_mask:0xf bank_mask:0xf
s_nop 1
v_max_f32_dpp v14, v14, v14 row_ror:4 row_mask:0xf bank_mask:0xf
s_nop 1
v_max_f32_dpp v14, v14, v14 row_ror:2 row_mask:0xf bank_mask:0xf
s_nop 1
v_max_f32_dpp v14, v14, v14 row_ror:1 row_mask:0xf bank_mask:0xf
v_mov_b32 v15, v14
s_nop 1
v_permlane32_swap_b32 v14, v15
v_max_f32 v14, v14, v15
v_max_f32 v14, v14, v52
v_sub_f32 v15, v52, v14
v_sub_f32 v16, v16, v14
v_mov_b32 v52, v14
v_mul_f32 v15, s88, v15
v_mul_f32 v16, s88, v16
v_exp_f32 v15, v15
v_exp_f32 v16, v16
s_nop 0
v_cvt_pk_bf16_f32 v13, v16, v16
v_fma_f32 v12, v12, v15, v16
v_mul_f32 v48, v48, v15
v_mul_f32 v49, v49, v15
v_mul_f32 v50, v50, v15
v_mul_f32 v51, v51, v15
s_branch v_loop
streamer:
s_xor_b32 s92, s90, 0x101000
v_dot2_f32_bf16 v32, v64, v4, 0
v_dot2_f32_bf16 v33, v68, v4, 0
v_dot2_f32_bf16 v32, v65, v5, v32
v_dot2_f32_bf16 v33, v69, v5, v33
v_dot2_f32_bf16 v32, v66, v6, v32
v_dot2_f32_bf16 v33, v70, v6, v33
v_dot2_f32_bf16 v32, v67, v7, v32
v_dot2_f32_bf16 v33, v71, v7, v33
v_dot2_f32_bf16 v34, v72, v4, 0
v_dot2_f32_bf16 v35, v76, v4, 0
v_dot2_f32_bf16 v34, v73, v5, v34
v_dot2_f32_bf16 v35, v77, v5, v35
v_dot2_f32_bf16 v34, v74, v6, v34
v_dot2_f32_bf16 v35, v78, v6, v35
v_dot2_f32_bf16 v34, v75, v7, v34
v_dot2_f32_bf16 v35, v79, v7, v35
v_dot2_f32_bf16 v36, v80, v4, 0
v_dot2_f32_bf16 v37, v84, v4, 0
v_dot2_f32_bf16 v36, v81, v5, v36
v_dot2_f32_bf16 v37, v85, v5, v37
v_dot2_f32_bf16 v36, v82, v6, v36
v_dot2_f32_bf16 v37, v86, v6, v37
v_dot2_f32_bf16 v36, v83, v7, v36
v_dot2_f32_bf16 v37, v87, v7, v37
v_dot2_f32_bf16 v38, v88, v4, 0
v_dot2_f32_bf16 v39, v92, v4, 0
v_dot2_f32_bf16 v38, v89, v5, v38
v_dot2_f32_bf16 v39, v93, v5, v39
v_dot2_f32_bf16 v38, v90, v6, v38
v_dot2_f32_bf16 v39, v94, v6, v39
v_dot2_f32_bf16 v38, v91, v7, v38
v_dot2_f32_bf16 v39, v95, v7, v39
v_dot2_f32_bf16 v40, v96, v4, 0
v_dot2_f32_bf16 v41, v100, v4, 0
v_dot2_f32_bf16 v40, v97, v5, v40
v_dot2_f32_bf16 v41, v101, v5, v41
v_dot2_f32_bf16 v40, v98, v6, v40
v_dot2_f32_bf16 v41, v102, v6, v41
v_dot2_f32_bf16 v40, v99, v7, v40
v_dot2_f32_bf16 v41, v103, v7, v41
v_dot2_f32_bf16 v42, v104, v4, 0
v_dot2_f32_bf16 v43, v108, v4, 0
v_dot2_f32_bf16 v42, v105, v5, v42
v_dot2_f32_bf16 v43, v109, v5, v43
v_dot2_f32_bf16 v42, v106, v6, v42
v_dot2_f32_bf16 v43, v110, v6, v43
v_dot2_f32_bf16 v42, v107, v7, v42
v_dot2_f32_bf16 v43, v111, v7, v43
v_dot2_f32_bf16 v44, v112, v4, 0
v_dot2_f32_bf16 v45, v116, v4, 0
v_dot2_f32_bf16 v44, v113, v5, v44
v_dot2_f32_bf16 v45, v117, v5, v45
v_dot2_f32_bf16 v44, v114, v6, v44
v_dot2_f32_bf16 v45, v118, v6, v45
v_dot2_f32_bf16 v44, v115, v7, v44
v_dot2_f32_bf16 v45, v119, v7, v45
s_waitcnt vmcnt(17)
v_dot2_f32_bf16 v46, v120, v4, 0
v_dot2_f32_bf16 v47, v124, v4, 0
v_dot2_f32_bf16 v46, v121, v5, v46
v_dot2_f32_bf16 v47, v125, v5, v47
v_dot2_f32_bf16 v46, v122, v6, v46
v_dot2_f32_bf16 v47, v126, v6, v47
v_dot2_f32_bf16 v46, v123, v7, v46
v_dot2_f32_bf16 v47, v127, v7, v47
buffer_load_dwordx4 v[64:67], v2, s[40:43], s92 offen offset:0 nt
v_add_f32_dpp v32, v32, v32 row_ror:8 row_mask:0xf bank_mask:0x3
v_add_f32_dpp v33, v33, v33 row_ror:8 row_mask:0xf bank_mask:0x3
v_add_f32_dpp v34, v34, v34 row_ror:8 row_mask:0xf bank_mask:0x3
buffer_load_dwordx4 v[68:71], v3, s[40:43], s92 offen offset:0 nt
v_add_f32_dpp v35, v35, v35 row_ror:8 row_mask:0xf bank_mask:0x3
v_add_f32_dpp v36, v36, v36 row_ror:8 row_mask:0xf bank_mask:0x3
v_add_f32_dpp v37, v37, v37 row_ror:8 row_mask:0xf bank_mask:0x3
buffer_load_dwordx4 v[72:75], v2, s[40:43], s92 offen offset:512 nt
v_add_f32_dpp v38, v38, v38 row_ror:8 row_mask:0xf bank_mask:0x3
v_add_f32_dpp v39, v39, v39 row_ror:8 row_mask:0xf bank_mask:0x3
v_add_f32_dpp v32, v40, v40 row_ror:8 row_mask:0xf bank_mask:0xc
buffer_load_dwordx4 v[76:79], v3, s[40:43], s92 offen offset:512 nt
v_add_f32_dpp v33, v41, v41 row_ror:8 row_mask:0xf bank_mask:0xc
v_add_f32_dpp v34, v42, v42 row_ror:8 row_mask:0xf bank_mask:0xc
v_add_f32_dpp v35, v43, v43 row_ror:8 row_mask:0xf bank_mask:0xc
buffer_load_dwordx4 v[80:83], v2, s[40:43], s92 offen offset:2048 nt
v_add_f32_dpp v36, v44, v44 row_ror:8 row_mask:0xf bank_mask:0xc
v_add_f32_dpp v37, v45, v45 row_ror:8 row_mask:0xf bank_mask:0xc
v_add_f32_dpp v38, v46, v46 row_ror:8 row_mask:0xf bank_mask:0xc
buffer_load_dwordx4 v[84:87], v3, s[40:43], s92 offen offset:2048 nt
v_add_f32_dpp v39, v47, v47 row_ror:8 row_mask:0xf bank_mask:0xc
v_add_f32_dpp v32, v32, v32 row_shl:4 row_mask:0xf bank_mask:0x5
v_add_f32_dpp v33, v33, v33 row_shl:4 row_mask:0xf bank_mask:0x5
buffer_load_dwordx4 v[88:91], v2, s[40:43], s92 offen offset:2560 nt
v_add_f32_dpp v34, v34, v34 row_shl:4 row_mask:0xf bank_mask:0x5
v_add_f32_dpp v35, v35, v35 row_shl:4 row_mask:0xf bank_mask:0x5
v_add_f32_dpp v32, v36, v36 row_shr:4 row_mask:0xf bank_mask:0xa
buffer_load_dwordx4 v[92:95], v3, s[40:43], s92 offen offset:2560 nt
v_add_f32_dpp v33, v37, v37 row_shr:4 row_mask:0xf bank_mask:0xa
v_add_f32_dpp v34, v38, v38 row_shr:4 row_mask:0xf bank_mask:0xa
v_add_f32_dpp v35, v39, v39 row_shr:4 row_mask:0xf bank_mask:0xa
buffer_load_dwordx4 v[96:99], v2, s[40:43], s92 offen offset:1024 nt
v_add_f32_dpp v32, v32, v32 quad_perm:[2,3,0,1] row_mask:0xf bank_mask:0xf
v_add_f32_dpp v33, v33, v33 quad_perm:[2,3,0,1] row_mask:0xf bank_mask:0xf
v_add_f32_dpp v34, v34, v34 quad_perm:[2,3,0,1] row_mask:0xf bank_mask:0xf
buffer_load_dwordx4 v[100:103], v3, s[40:43], s92 offen offset:1024 nt
v_add_f32_dpp v35, v35, v35 quad_perm:[2,3,0,1] row_mask:0xf bank_mask:0xf
v_cndmask_b32 v32, v32, v34, s[84:85]
v_cndmask_b32 v33, v33, v35, s[84:85]
buffer_load_dwordx4 v[104:107], v2, s[40:43], s92 offen offset:1536 nt
v_add_f32_dpp v32, v32, v32 quad_perm:[1,0,3,2] row_mask:0xf bank_mask:0xf
v_add_f32_dpp v33, v33, v33 quad_perm:[1,0,3,2] row_mask:0xf bank_mask:0xf
v_cndmask_b32 v32, v32, v33, s[86:87]
buffer_load_dwordx4 v[108:111], v3, s[40:43], s92 offen offset:1536 nt
v_mov_b32 v33, v32
s_nop 1
v_permlane16_swap_b32 v32, v33
v_add_f32 v32, v32, v33
buffer_load_dwordx4 v[112:115], v2, s[40:43], s92 offen offset:3072 nt
v_mov_b32 v33, v32
s_nop 1
v_permlane32_swap_b32 v32, v33
v_cvt_pk_bf16_f32 v54, v32, v33
buffer_load_dwordx4 v[116:119], v3, s[40:43], s92 offen offset:3072 nt
ds_write_b32 v8, v54
v_add_u32 v8, 64, v8
buffer_load_dwordx4 v[120:123], v2, s[40:43], s92 offen offset:3584 nt
buffer_load_dwordx4 v[124:127], v3, s[40:43], s92 offen offset:3584 nt
s_xor_b32 s92, s92, 0x202000
s_waitcnt vmcnt(31)
v_dot2_f32_bf16 v32, v128, v4, 0
v_dot2_f32_bf16 v33, v132, v4, 0
v_dot2_f32_bf16 v32, v129, v5, v32
v_dot2_f32_bf16 v33, v133, v5, v33
v_dot2_f32_bf16 v32, v130, v6, v32
v_dot2_f32_bf16 v33, v134, v6, v33
v_dot2_f32_bf16 v32, v131, v7, v32
v_dot2_f32_bf16 v33, v135, v7, v33
s_waitcnt vmcnt(29)
v_dot2_f32_bf16 v34, v136, v4, 0
v_dot2_f32_bf16 v35, v140, v4, 0
v_dot2_f32_bf16 v34, v137, v5, v34
v_dot2_f32_bf16 v35, v141, v5, v35
v_dot2_f32_bf16 v34, v138, v6, v34
v_dot2_f32_bf16 v35, v142, v6, v35
v_dot2_f32_bf16 v34, v139, v7, v34
v_dot2_f32_bf16 v35, v143, v7, v35
s_waitcnt vmcnt(27)
v_dot2_f32_bf16 v36, v144, v4, 0
v_dot2_f32_bf16 v37, v148, v4, 0
v_dot2_f32_bf16 v36, v145, v5, v36
v_dot2_f32_bf16 v37, v149, v5, v37
v_dot2_f32_bf16 v36, v146, v6, v36
v_dot2_f32_bf16 v37, v150, v6, v37
v_dot2_f32_bf16 v36, v147, v7, v36
v_dot2_f32_bf16 v37, v151, v7, v37
s_waitcnt vmcnt(25)
v_dot2_f32_bf16 v38, v152, v4, 0
v_dot2_f32_bf16 v39, v156, v4, 0
v_dot2_f32_bf16 v38, v153, v5, v38
v_dot2_f32_bf16 v39, v157, v5, v39
v_dot2_f32_bf16 v38, v154, v6, v38
v_dot2_f32_bf16 v39, v158, v6, v39
v_dot2_f32_bf16 v38, v155, v7, v38
v_dot2_f32_bf16 v39, v159, v7, v39
s_waitcnt vmcnt(23)
v_dot2_f32_bf16 v40, v160, v4, 0
v_dot2_f32_bf16 v41, v164, v4, 0
v_dot2_f32_bf16 v40, v161, v5, v40
v_dot2_f32_bf16 v41, v165, v5, v41
v_dot2_f32_bf16 v40, v162, v6, v40
v_dot2_f32_bf16 v41, v166, v6, v41
v_dot2_f32_bf16 v40, v163, v7, v40
v_dot2_f32_bf16 v41, v167, v7, v41
s_waitcnt vmcnt(21)
v_dot2_f32_bf16 v42, v168, v4, 0
v_dot2_f32_bf16 v43, v172, v4, 0
v_dot2_f32_bf16 v42, v169, v5, v42
v_dot2_f32_bf16 v43, v173, v5, v43
v_dot2_f32_bf16 v42, v170, v6, v42
v_dot2_f32_bf16 v43, v174, v6, v43
v_dot2_f32_bf16 v42, v171, v7, v42
v_dot2_f32_bf16 v43, v175, v7, v43
s_waitcnt vmcnt(19)
v_dot2_f32_bf16 v44, v176, v4, 0
v_dot2_f32_bf16 v45, v180, v4, 0
v_dot2_f32_bf16 v44, v177, v5, v44
v_dot2_f32_bf16 v45, v181, v5, v45
v_dot2_f32_bf16 v44, v178, v6, v44
v_dot2_f32_bf16 v45, v182, v6, v45
v_dot2_f32_bf16 v44, v179, v7, v44
v_dot2_f32_bf16 v45, v183, v7, v45
s_waitcnt vmcnt(17)
v_dot2_f32_bf16 v46, v184, v4, 0
v_dot2_f32_bf16 v47, v188, v4, 0
v_dot2_f32_bf16 v46, v185, v5, v46
v_dot2_f32_bf16 v47, v189, v5, v47
v_dot2_f32_bf16 v46, v186, v6, v46
v_dot2_f32_bf16 v47, v190, v6, v47
v_dot2_f32_bf16 v46, v187, v7, v46
v_dot2_f32_bf16 v47, v191, v7, v47
buffer_load_dwordx4 v[128:131], v2, s[40:43], s92 offen offset:0 nt
v_add_f32_dpp v32, v32, v32 row_ror:8 row_mask:0xf bank_mask:0x3
v_add_f32_dpp v33, v33, v33 row_ror:8 row_mask:0xf bank_mask:0x3
v_add_f32_dpp v34, v34, v34 row_ror:8 row_mask:0xf bank_mask:0x3
buffer_load_dwordx4 v[132:135], v3, s[40:43], s92 offen offset:0 nt
v_add_f32_dpp v35, v35, v35 row_ror:8 row_mask:0xf bank_mask:0x3
v_add_f32_dpp v36, v36, v36 row_ror:8 row_mask:0xf bank_mask:0x3
v_add_f32_dpp v37, v37, v37 row_ror:8 row_mask:0xf bank_mask:0x3
buffer_load_dwordx4 v[136:139], v2, s[40:43], s92 offen offset:512 nt
v_add_f32_dpp v38, v38, v38 row_ror:8 row_mask:0xf bank_mask:0x3
v_add_f32_dpp v39, v39, v39 row_ror:8 row_mask:0xf bank_mask:0x3
v_add_f32_dpp v32, v40, v40 row_ror:8 row_mask:0xf bank_mask:0xc
buffer_load_dwordx4 v[140:143], v3, s[40:43], s92 offen offset:512 nt
v_add_f32_dpp v33, v41, v41 row_ror:8 row_mask:0xf bank_mask:0xc
v_add_f32_dpp v34, v42, v42 row_ror:8 row_mask:0xf bank_mask:0xc
v_add_f32_dpp v35, v43, v43 row_ror:8 row_mask:0xf bank_mask:0xc
buffer_load_dwordx4 v[144:147], v2, s[40:43], s92 offen offset:2048 nt
v_add_f32_dpp v36, v44, v44 row_ror:8 row_mask:0xf bank_mask:0xc
v_add_f32_dpp v37, v45, v45 row_ror:8 row_mask:0xf bank_mask:0xc
v_add_f32_dpp v38, v46, v46 row_ror:8 row_mask:0xf bank_mask:0xc
buffer_load_dwordx4 v[148:151], v3, s[40:43], s92 offen offset:2048 nt
v_add_f32_dpp v39, v47, v47 row_ror:8 row_mask:0xf bank_mask:0xc
v_add_f32_dpp v32, v32, v32 row_shl:4 row_mask:0xf bank_mask:0x5
v_add_f32_dpp v33, v33, v33 row_shl:4 row_mask:0xf bank_mask:0x5
buffer_load_dwordx4 v[152:155], v2, s[40:43], s92 offen offset:2560 nt
v_add_f32_dpp v34, v34, v34 row_shl:4 row_mask:0xf bank_mask:0x5
v_add_f32_dpp v35, v35, v35 row_shl:4 row_mask:0xf bank_mask:0x5
v_add_f32_dpp v32, v36, v36 row_shr:4 row_mask:0xf bank_mask:0xa
buffer_load_dwordx4 v[156:159], v3, s[40:43], s92 offen offset:2560 nt
v_add_f32_dpp v33, v37, v37 row_shr:4 row_mask:0xf bank_mask:0xa
v_add_f32_dpp v34, v38, v38 row_shr:4 row_mask:0xf bank_mask:0xa
v_add_f32_dpp v35, v39, v39 row_shr:4 row_mask:0xf bank_mask:0xa
buffer_load_dwordx4 v[160:163], v2, s[40:43], s92 offen offset:1024 nt
v_add_f32_dpp v32, v32, v32 quad_perm:[2,3,0,1] row_mask:0xf bank_mask:0xf
v_add_f32_dpp v33, v33, v33 quad_perm:[2,3,0,1] row_mask:0xf bank_mask:0xf
v_add_f32_dpp v34, v34, v34 quad_perm:[2,3,0,1] row_mask:0xf bank_mask:0xf
buffer_load_dwordx4 v[164:167], v3, s[40:43], s92 offen offset:1024 nt
v_add_f32_dpp v35, v35, v35 quad_perm:[2,3,0,1] row_mask:0xf bank_mask:0xf
v_cndmask_b32 v32, v32, v34, s[84:85]
v_cndmask_b32 v33, v33, v35, s[84:85]
buffer_load_dwordx4 v[168:171], v2, s[40:43], s92 offen offset:1536 nt
v_add_f32_dpp v32, v32, v32 quad_perm:[1,0,3,2] row_mask:0xf bank_mask:0xf
v_add_f32_dpp v33, v33, v33 quad_perm:[1,0,3,2] row_mask:0xf bank_mask:0xf
v_cndmask_b32 v32, v32, v33, s[86:87]
buffer_load_dwordx4 v[172:175], v3, s[40:43], s92 offen offset:1536 nt
v_mov_b32 v33, v32
s_nop 1
v_permlane16_swap_b32 v32, v33
v_add_f32 v32, v32, v33
buffer_load_dwordx4 v[176:179], v2, s[40:43], s92 offen offset:3072 nt
v_mov_b32 v33, v32
s_nop 1
v_permlane32_swap_b32 v32, v33
v_cvt_pk_bf16_f32 v54, v32, v33
buffer_load_dwordx4 v[180:183], v3, s[40:43], s92 offen offset:3072 nt
ds_write_b32 v8, v54
v_add_u32 v8, 64, v8
buffer_load_dwordx4 v[184:187], v2, s[40:43], s92 offen offset:3584 nt
buffer_load_dwordx4 v[188:191], v3, s[40:43], s92 offen offset:3584 nt
v_add_u32 v8, 384, v8
s_barrier
s_xor_b32 s92, s90, 0x585000
buffer_load_dwordx4 v[60:63], v17, s[48:51], s12 offen sc1
s_waitcnt vmcnt(31)
v_dot2_f32_bf16 v32, v64, v4, 0
v_dot2_f32_bf16 v33, v68, v4, 0
v_dot2_f32_bf16 v32, v65, v5, v32
v_dot2_f32_bf16 v33, v69, v5, v33
v_dot2_f32_bf16 v32, v66, v6, v32
v_dot2_f32_bf16 v33, v70, v6, v33
v_dot2_f32_bf16 v32, v67, v7, v32
v_dot2_f32_bf16 v33, v71, v7, v33
s_waitcnt vmcnt(29)
v_dot2_f32_bf16 v34, v72, v4, 0
v_dot2_f32_bf16 v35, v76, v4, 0
v_dot2_f32_bf16 v34, v73, v5, v34
v_dot2_f32_bf16 v35, v77, v5, v35
v_dot2_f32_bf16 v34, v74, v6, v34
v_dot2_f32_bf16 v35, v78, v6, v35
v_dot2_f32_bf16 v34, v75, v7, v34
v_dot2_f32_bf16 v35, v79, v7, v35
s_waitcnt vmcnt(27)
v_dot2_f32_bf16 v36, v80, v4, 0
v_dot2_f32_bf16 v37, v84, v4, 0
v_dot2_f32_bf16 v36, v81, v5, v36
v_dot2_f32_bf16 v37, v85, v5, v37
v_dot2_f32_bf16 v36, v82, v6, v36
v_dot2_f32_bf16 v37, v86, v6, v37
v_dot2_f32_bf16 v36, v83, v7, v36
v_dot2_f32_bf16 v37, v87, v7, v37
s_waitcnt vmcnt(25)
v_dot2_f32_bf16 v38, v88, v4, 0
v_dot2_f32_bf16 v39, v92, v4, 0
v_dot2_f32_bf16 v38, v89, v5, v38
v_dot2_f32_bf16 v39, v93, v5, v39
v_dot2_f32_bf16 v38, v90, v6, v38
v_dot2_f32_bf16 v39, v94, v6, v39
v_dot2_f32_bf16 v38, v91, v7, v38
v_dot2_f32_bf16 v39, v95, v7, v39
s_waitcnt vmcnt(23)
v_dot2_f32_bf16 v40, v96, v4, 0
v_dot2_f32_bf16 v41, v100, v4, 0
v_dot2_f32_bf16 v40, v97, v5, v40
v_dot2_f32_bf16 v41, v101, v5, v41
v_dot2_f32_bf16 v40, v98, v6, v40
v_dot2_f32_bf16 v41, v102, v6, v41
v_dot2_f32_bf16 v40, v99, v7, v40
v_dot2_f32_bf16 v41, v103, v7, v41
s_waitcnt vmcnt(21)
v_dot2_f32_bf16 v42, v104, v4, 0
v_dot2_f32_bf16 v43, v108, v4, 0
v_dot2_f32_bf16 v42, v105, v5, v42
v_dot2_f32_bf16 v43, v109, v5, v43
v_dot2_f32_bf16 v42, v106, v6, v42
v_dot2_f32_bf16 v43, v110, v6, v43
v_dot2_f32_bf16 v42, v107, v7, v42
v_dot2_f32_bf16 v43, v111, v7, v43
s_waitcnt vmcnt(19)
v_dot2_f32_bf16 v44, v112, v4, 0
v_dot2_f32_bf16 v45, v116, v4, 0
v_dot2_f32_bf16 v44, v113, v5, v44
v_dot2_f32_bf16 v45, v117, v5, v45
v_dot2_f32_bf16 v44, v114, v6, v44
v_dot2_f32_bf16 v45, v118, v6, v45
v_dot2_f32_bf16 v44, v115, v7, v44
v_dot2_f32_bf16 v45, v119, v7, v45
s_waitcnt vmcnt(17)
v_dot2_f32_bf16 v46, v120, v4, 0
v_dot2_f32_bf16 v47, v124, v4, 0
v_dot2_f32_bf16 v46, v121, v5, v46
v_dot2_f32_bf16 v47, v125, v5, v47
v_dot2_f32_bf16 v46, v122, v6, v46
v_dot2_f32_bf16 v47, v126, v6, v47
v_dot2_f32_bf16 v46, v123, v7, v46
v_dot2_f32_bf16 v47, v127, v7, v47
buffer_load_dwordx4 v[64:67], v2, s[40:43], s92 offen offset:0 nt
v_add_f32_dpp v32, v32, v32 row_ror:8 row_mask:0xf bank_mask:0x3
v_add_f32_dpp v33, v33, v33 row_ror:8 row_mask:0xf bank_mask:0x3
v_add_f32_dpp v34, v34, v34 row_ror:8 row_mask:0xf bank_mask:0x3
buffer_load_dwordx4 v[68:71], v3, s[40:43], s92 offen offset:0 nt
v_add_f32_dpp v35, v35, v35 row_ror:8 row_mask:0xf bank_mask:0x3
v_add_f32_dpp v36, v36, v36 row_ror:8 row_mask:0xf bank_mask:0x3
v_add_f32_dpp v37, v37, v37 row_ror:8 row_mask:0xf bank_mask:0x3
buffer_load_dwordx4 v[72:75], v2, s[40:43], s92 offen offset:512 nt
v_add_f32_dpp v38, v38, v38 row_ror:8 row_mask:0xf bank_mask:0x3
v_add_f32_dpp v39, v39, v39 row_ror:8 row_mask:0xf bank_mask:0x3
v_add_f32_dpp v32, v40, v40 row_ror:8 row_mask:0xf bank_mask:0xc
buffer_load_dwordx4 v[76:79], v3, s[40:43], s92 offen offset:512 nt
v_add_f32_dpp v33, v41, v41 row_ror:8 row_mask:0xf bank_mask:0xc
v_add_f32_dpp v34, v42, v42 row_ror:8 row_mask:0xf bank_mask:0xc
v_add_f32_dpp v35, v43, v43 row_ror:8 row_mask:0xf bank_mask:0xc
buffer_load_dwordx4 v[80:83], v2, s[40:43], s92 offen offset:2048 nt
v_add_f32_dpp v36, v44, v44 row_ror:8 row_mask:0xf bank_mask:0xc
v_add_f32_dpp v37, v45, v45 row_ror:8 row_mask:0xf bank_mask:0xc
v_add_f32_dpp v38, v46, v46 row_ror:8 row_mask:0xf bank_mask:0xc
buffer_load_dwordx4 v[84:87], v3, s[40:43], s92 offen offset:2048 nt
v_add_f32_dpp v39, v47, v47 row_ror:8 row_mask:0xf bank_mask:0xc
v_add_f32_dpp v32, v32, v32 row_shl:4 row_mask:0xf bank_mask:0x5
v_add_f32_dpp v33, v33, v33 row_shl:4 row_mask:0xf bank_mask:0x5
buffer_load_dwordx4 v[88:91], v2, s[40:43], s92 offen offset:2560 nt
v_add_f32_dpp v34, v34, v34 row_shl:4 row_mask:0xf bank_mask:0x5
v_add_f32_dpp v35, v35, v35 row_shl:4 row_mask:0xf bank_mask:0x5
v_add_f32_dpp v32, v36, v36 row_shr:4 row_mask:0xf bank_mask:0xa
buffer_load_dwordx4 v[92:95], v3, s[40:43], s92 offen offset:2560 nt
v_add_f32_dpp v33, v37, v37 row_shr:4 row_mask:0xf bank_mask:0xa
v_add_f32_dpp v34, v38, v38 row_shr:4 row_mask:0xf bank_mask:0xa
v_add_f32_dpp v35, v39, v39 row_shr:4 row_mask:0xf bank_mask:0xa
buffer_load_dwordx4 v[96:99], v2, s[40:43], s92 offen offset:1024 nt
v_add_f32_dpp v32, v32, v32 quad_perm:[2,3,0,1] row_mask:0xf bank_mask:0xf
v_add_f32_dpp v33, v33, v33 quad_perm:[2,3,0,1] row_mask:0xf bank_mask:0xf
v_add_f32_dpp v34, v34, v34 quad_perm:[2,3,0,1] row_mask:0xf bank_mask:0xf
buffer_load_dwordx4 v[100:103], v3, s[40:43], s92 offen offset:1024 nt
v_add_f32_dpp v35, v35, v35 quad_perm:[2,3,0,1] row_mask:0xf bank_mask:0xf
v_cndmask_b32 v32, v32, v34, s[84:85]
v_cndmask_b32 v33, v33, v35, s[84:85]
buffer_load_dwordx4 v[104:107], v2, s[40:43], s92 offen offset:1536 nt
v_add_f32_dpp v32, v32, v32 quad_perm:[1,0,3,2] row_mask:0xf bank_mask:0xf
v_add_f32_dpp v33, v33, v33 quad_perm:[1,0,3,2] row_mask:0xf bank_mask:0xf
v_cndmask_b32 v32, v32, v33, s[86:87]
buffer_load_dwordx4 v[108:111], v3, s[40:43], s92 offen offset:1536 nt
v_mov_b32 v33, v32
s_nop 1
v_permlane16_swap_b32 v32, v33
v_add_f32 v32, v32, v33
buffer_load_dwordx4 v[112:115], v2, s[40:43], s92 offen offset:3072 nt
v_mov_b32 v33, v32
s_nop 1
v_permlane32_swap_b32 v32, v33
v_cvt_pk_bf16_f32 v54, v32, v33
buffer_load_dwordx4 v[116:119], v3, s[40:43], s92 offen offset:3072 nt
ds_write_b32 v8, v54
v_add_u32 v8, 64, v8
buffer_load_dwordx4 v[120:123], v2, s[40:43], s92 offen offset:3584 nt
buffer_load_dwordx4 v[124:127], v3, s[40:43], s92 offen offset:3584 nt
s_xor_b32 s92, s92, 0x202000
s_waitcnt vmcnt(31)
v_dot2_f32_bf16 v32, v128, v4, 0
v_dot2_f32_bf16 v33, v132, v4, 0
v_dot2_f32_bf16 v32, v129, v5, v32
v_dot2_f32_bf16 v33, v133, v5, v33
v_dot2_f32_bf16 v32, v130, v6, v32
v_dot2_f32_bf16 v33, v134, v6, v33
v_dot2_f32_bf16 v32, v131, v7, v32
v_dot2_f32_bf16 v33, v135, v7, v33
s_waitcnt vmcnt(29)
v_dot2_f32_bf16 v34, v136, v4, 0
v_dot2_f32_bf16 v35, v140, v4, 0
v_dot2_f32_bf16 v34, v137, v5, v34
v_dot2_f32_bf16 v35, v141, v5, v35
v_dot2_f32_bf16 v34, v138, v6, v34
v_dot2_f32_bf16 v35, v142, v6, v35
v_dot2_f32_bf16 v34, v139, v7, v34
v_dot2_f32_bf16 v35, v143, v7, v35
s_waitcnt vmcnt(27)
v_dot2_f32_bf16 v36, v144, v4, 0
v_dot2_f32_bf16 v37, v148, v4, 0
v_dot2_f32_bf16 v36, v145, v5, v36
v_dot2_f32_bf16 v37, v149, v5, v37
v_dot2_f32_bf16 v36, v146, v6, v36
v_dot2_f32_bf16 v37, v150, v6, v37
v_dot2_f32_bf16 v36, v147, v7, v36
v_dot2_f32_bf16 v37, v151, v7, v37
s_waitcnt vmcnt(25)
v_dot2_f32_bf16 v38, v152, v4, 0
v_dot2_f32_bf16 v39, v156, v4, 0
v_dot2_f32_bf16 v38, v153, v5, v38
v_dot2_f32_bf16 v39, v157, v5, v39
v_dot2_f32_bf16 v38, v154, v6, v38
v_dot2_f32_bf16 v39, v158, v6, v39
v_dot2_f32_bf16 v38, v155, v7, v38
v_dot2_f32_bf16 v39, v159, v7, v39
s_waitcnt vmcnt(23)
v_dot2_f32_bf16 v40, v160, v4, 0
v_dot2_f32_bf16 v41, v164, v4, 0
v_dot2_f32_bf16 v40, v161, v5, v40
v_dot2_f32_bf16 v41, v165, v5, v41
v_dot2_f32_bf16 v40, v162, v6, v40
v_dot2_f32_bf16 v41, v166, v6, v41
v_dot2_f32_bf16 v40, v163, v7, v40
v_dot2_f32_bf16 v41, v167, v7, v41
s_waitcnt vmcnt(21)
v_dot2_f32_bf16 v42, v168, v4, 0
v_dot2_f32_bf16 v43, v172, v4, 0
v_dot2_f32_bf16 v42, v169, v5, v42
v_dot2_f32_bf16 v43, v173, v5, v43
v_dot2_f32_bf16 v42, v170, v6, v42
v_dot2_f32_bf16 v43, v174, v6, v43
v_dot2_f32_bf16 v42, v171, v7, v42
v_dot2_f32_bf16 v43, v175, v7, v43
s_waitcnt vmcnt(19)
v_dot2_f32_bf16 v44, v176, v4, 0
v_dot2_f32_bf16 v45, v180, v4, 0
v_dot2_f32_bf16 v44, v177, v5, v44
v_dot2_f32_bf16 v45, v181, v5, v45
v_dot2_f32_bf16 v44, v178, v6, v44
v_dot2_f32_bf16 v45, v182, v6, v45
v_dot2_f32_bf16 v44, v179, v7, v44
v_dot2_f32_bf16 v45, v183, v7, v45
s_waitcnt vmcnt(17)
v_dot2_f32_bf16 v46, v184, v4, 0
v_dot2_f32_bf16 v47, v188, v4, 0
v_dot2_f32_bf16 v46, v185, v5, v46
v_dot2_f32_bf16 v47, v189, v5, v47
v_dot2_f32_bf16 v46, v186, v6, v46
v_dot2_f32_bf16 v47, v190, v6, v47
v_dot2_f32_bf16 v46, v187, v7, v46
v_dot2_f32_bf16 v47, v191, v7, v47
buffer_load_dwordx4 v[128:131], v2, s[40:43], s92 offen offset:0 nt
v_add_f32_dpp v32, v32, v32 row_ror:8 row_mask:0xf bank_mask:0x3
v_add_f32_dpp v33, v33, v33 row_ror:8 row_mask:0xf bank_mask:0x3
v_add_f32_dpp v34, v34, v34 row_ror:8 row_mask:0xf bank_mask:0x3
buffer_load_dwordx4 v[132:135], v3, s[40:43], s92 offen offset:0 nt
v_add_f32_dpp v35, v35, v35 row_ror:8 row_mask:0xf bank_mask:0x3
v_add_f32_dpp v36, v36, v36 row_ror:8 row_mask:0xf bank_mask:0x3
v_add_f32_dpp v37, v37, v37 row_ror:8 row_mask:0xf bank_mask:0x3
buffer_load_dwordx4 v[136:139], v2, s[40:43], s92 offen offset:512 nt
v_add_f32_dpp v38, v38, v38 row_ror:8 row_mask:0xf bank_mask:0x3
v_add_f32_dpp v39, v39, v39 row_ror:8 row_mask:0xf bank_mask:0x3
v_add_f32_dpp v32, v40, v40 row_ror:8 row_mask:0xf bank_mask:0xc
buffer_load_dwordx4 v[140:143], v3, s[40:43], s92 offen offset:512 nt
v_add_f32_dpp v33, v41, v41 row_ror:8 row_mask:0xf bank_mask:0xc
v_add_f32_dpp v34, v42, v42 row_ror:8 row_mask:0xf bank_mask:0xc
v_add_f32_dpp v35, v43, v43 row_ror:8 row_mask:0xf bank_mask:0xc
buffer_load_dwordx4 v[144:147], v2, s[40:43], s92 offen offset:2048 nt
v_add_f32_dpp v36, v44, v44 row_ror:8 row_mask:0xf bank_mask:0xc
v_add_f32_dpp v37, v45, v45 row_ror:8 row_mask:0xf bank_mask:0xc
v_add_f32_dpp v38, v46, v46 row_ror:8 row_mask:0xf bank_mask:0xc
buffer_load_dwordx4 v[148:151], v3, s[40:43], s92 offen offset:2048 nt
v_add_f32_dpp v39, v47, v47 row_ror:8 row_mask:0xf bank_mask:0xc
v_add_f32_dpp v32, v32, v32 row_shl:4 row_mask:0xf bank_mask:0x5
v_add_f32_dpp v33, v33, v33 row_shl:4 row_mask:0xf bank_mask:0x5
buffer_load_dwordx4 v[152:155], v2, s[40:43], s92 offen offset:2560 nt
v_add_f32_dpp v34, v34, v34 row_shl:4 row_mask:0xf bank_mask:0x5
v_add_f32_dpp v35, v35, v35 row_shl:4 row_mask:0xf bank_mask:0x5
v_add_f32_dpp v32, v36, v36 row_shr:4 row_mask:0xf bank_mask:0xa
buffer_load_dwordx4 v[156:159], v3, s[40:43], s92 offen offset:2560 nt
v_add_f32_dpp v33, v37, v37 row_shr:4 row_mask:0xf bank_mask:0xa
v_add_f32_dpp v34, v38, v38 row_shr:4 row_mask:0xf bank_mask:0xa
v_add_f32_dpp v35, v39, v39 row_shr:4 row_mask:0xf bank_mask:0xa
buffer_load_dwordx4 v[160:163], v2, s[40:43], s92 offen offset:1024 nt
v_add_f32_dpp v32, v32, v32 quad_perm:[2,3,0,1] row_mask:0xf bank_mask:0xf
v_add_f32_dpp v33, v33, v33 quad_perm:[2,3,0,1] row_mask:0xf bank_mask:0xf
v_add_f32_dpp v34, v34, v34 quad_perm:[2,3,0,1] row_mask:0xf bank_mask:0xf
buffer_load_dwordx4 v[164:167], v3, s[40:43], s92 offen offset:1024 nt
v_add_f32_dpp v35, v35, v35 quad_perm:[2,3,0,1] row_mask:0xf bank_mask:0xf
v_cndmask_b32 v32, v32, v34, s[84:85]
v_cndmask_b32 v33, v33, v35, s[84:85]
buffer_load_dwordx4 v[168:171], v2, s[40:43], s92 offen offset:1536 nt
v_add_f32_dpp v32, v32, v32 quad_perm:[1,0,3,2] row_mask:0xf bank_mask:0xf
v_add_f32_dpp v33, v33, v33 quad_perm:[1,0,3,2] row_mask:0xf bank_mask:0xf
v_cndmask_b32 v32, v32, v33, s[86:87]
buffer_load_dwordx4 v[172:175], v3, s[40:43], s92 offen offset:1536 nt
v_mov_b32 v33, v32
s_nop 1
v_permlane16_swap_b32 v32, v33
v_add_f32 v32, v32, v33
buffer_load_dwordx4 v[176:179], v2, s[40:43], s92 offen offset:3072 nt
v_mov_b32 v33, v32
s_nop 1
v_permlane32_swap_b32 v32, v33
v_cvt_pk_bf16_f32 v54, v32, v33
buffer_load_dwordx4 v[180:183], v3, s[40:43], s92 offen offset:3072 nt
ds_write_b32 v8, v54
v_add_u32 v8, 64, v8
buffer_load_dwordx4 v[184:187], v2, s[40:43], s92 offen offset:3584 nt
buffer_load_dwordx4 v[188:191], v3, s[40:43], s92 offen offset:3584 nt
s_mov_b32 s96, 200000
s_waitcnt vmcnt(32)
vt_chk:
v_xor_b32 v32, s89, v60
v_xor_b32 v33, s89, v61
v_xor_b32 v34, s89, v62
v_xor_b32 v35, s89, v63
v_cmp_gt_u32 s[60:61], 64, v32
v_cmp_gt_u32 s[62:63], 64, v33
v_cmp_gt_u32 s[64:65], 64, v34
v_cmp_gt_u32 s[66:67], 64, v35
v_and_b32 v32, 1, v60
v_and_b32 v36, 2, v60
v_and_b32 v33, 1, v61
v_and_b32 v37, 2, v61
v_and_b32 v34, 1, v62
v_and_b32 v38, 2, v62
v_and_b32 v35, 1, v63
v_and_b32 v39, 2, v63
v_lshlrev_b32 v36, 9, v36
v_lshlrev_b32 v37, 9, v37
v_lshlrev_b32 v38, 9, v38
v_lshlrev_b32 v39, 9, v39
v_or3_b32 v32, v32, v36, s77
v_or3_b32 v33, v33, v37, s77
v_or3_b32 v34, v34, v38, s77
v_or3_b32 v35, v35, v39, s77
v_cndmask_b32 v32, 0, v32, s[60:61]
v_cndmask_b32 v33, 0, v33, s[62:63]
v_cndmask_b32 v34, 0, v34, s[64:65]
v_cndmask_b32 v35, 0, v35, s[66:67]
v_add3_u32 v32, v32, v33, v34
v_add_u32 v32, v32, v35
s_andn2_b32 s8, s2, 4
s_lshr_b32 s8, s8, 2
v_readlane_b32 s72, v60, s8
v_readlane_b32 s73, v61, s8
v_readlane_b32 s74, v62, s8
v_readlane_b32 s75, v63, s8
v_add_u32_dpp v32, v32, v32 row_ror:8 row_mask:0xf bank_mask:0xf
s_nop 1
v_add_u32_dpp v32, v32, v32 row_ror:4 row_mask:0xf bank_mask:0xf
s_nop 1
v_add_u32_dpp v32, v32, v32 row_ror:2 row_mask:0xf bank_mask:0xf
s_nop 1
v_add_u32_dpp v32, v32, v32 row_ror:1 row_mask:0xf bank_mask:0xf
v_mov_b32 v33, v32
s_nop 1
v_permlane16_swap_b32 v32, v33
v_add_u32 v32, v32, v33
v_mov_b32 v33, v32
s_nop 1
v_permlane32_swap_b32 v32, v33
v_add_u32 v32, v32, v33
s_bitcmp1_b32 s2, 0
s_cselect_b32 s72, s73, s72
s_cselect_b32 s74, s75, s74
s_bitcmp1_b32 s2, 1
s_cselect_b32 s72, s74, s72
v_readfirstlane_b32 s8, v32
s_nop 0
s_lshr_b32 s73, s8, 20
s_and_b32 s74, s8, 0x3ff
s_bfe_u32 s75, s8, 0xa000a
s_bfe_u32 s9, s72, 0x10004
s_lshl_b32 s9, s9, 2
s_cmp_gt_u32 s74, 128
s_cselect_b32 s8, 1, 0
s_or_b32 s9, s9, s8
s_cmp_gt_u32 s75, 128
s_cselect_b32 s8, 2, 0
s_or_b32 s9, s9, s8
s_sub_u32 s8, s73, s74
s_add_u32 s8, s8, 1
s_max_u32 s74, s74, s8
s_sub_u32 s8, s73, s75
s_add_u32 s8, s8, 1
s_max_u32 s75, s75, s8
s_min_u32 s74, s74, s75
s_xor_b32 s72, s72, s89
s_cmp_lt_u32 s72, 64
s_cselect_b32 s74, s74, 0
s_cmp_gt_u32 s74, 128
s_cbranch_scc0 vt_spin
vt_ok:
s_lshr_b32 s8, s9, 2
s_xor_b32 s4, s4, s8
s_lshr_b32 s8, s9, 1
s_xor_b32 s8, s8, s4
s_and_b32 s8, s8, 1
s_lshl_b32 s8, s8, 13
s_xor_b32 s91, s83, s8
s_xor_b32 s93, s90, s91
s_bfe_u32 s8, s93, 0x1000e
s_xor_b32 s6, s2, s8
s_bfe_u32 s8, s93, 0x1000c
s_lshl_b32 s8, s8, 1
s_xor_b32 s6, s6, s8
s_bfe_u32 s8, s93, 0x1000d
s_lshl_b32 s8, s8, 2
s_xor_b32 s6, s6, s8
s_cmp_lg_u32 s6, s2
s_cselect_b32 s93, 0x2000, 0
s_xor_b32 s8, s9, s4
s_and_b32 s8, s8, 1
s_lshl_b32 s8, s8, 13
s_xor_b32 s90, s83, s8
s_xor_b32 s8, s90, s91
s_lshl_b32 s8, s8, 1
s_or_b32 s93, s93, s8
v_mov_b32 v32, 0
v_mov_b32 v36, s91
v_mov_b32 v37, s93
v_mov_b32 v38, s6
ds_write_b96 v32, v[36:38] offset:560
s_mov_b32 s94, 12
k_loop:
s_mov_b32 s92, s90
s_bitcmp1_b32 s94, 1
s_cselect_b32 s95, 0x484000, 0
s_xor_b32 s92, s92, s95
s_bitcmp1_b32 s94, 2
s_cselect_b32 s95, 0x901000, 0
s_xor_b32 s92, s92, s95
s_bitcmp1_b32 s94, 3
s_cselect_b32 s95, 0x101000, 0
s_xor_b32 s92, s92, s95
s_bitcmp1_b32 s94, 4
s_cselect_b32 s95, 0x40000, 0
s_xor_b32 s92, s92, s95
s_bitcmp1_b32 s94, 5
s_cselect_b32 s95, 0x20000, 0
s_xor_b32 s92, s92, s95
s_waitcnt vmcnt(30)
v_dot2_f32_bf16 v32, v64, v4, 0
v_dot2_f32_bf16 v33, v68, v4, 0
v_dot2_f32_bf16 v32, v65, v5, v32
v_dot2_f32_bf16 v33, v69, v5, v33
v_dot2_f32_bf16 v32, v66, v6, v32
v_dot2_f32_bf16 v33, v70, v6, v33
v_dot2_f32_bf16 v32, v67, v7, v32
v_dot2_f32_bf16 v33, v71, v7, v33
s_waitcnt vmcnt(28)
v_dot2_f32_bf16 v34, v72, v4, 0
v_dot2_f32_bf16 v35, v76, v4, 0
v_dot2_f32_bf16 v34, v73, v5, v34
v_dot2_f32_bf16 v35, v77, v5, v35
v_dot2_f32_bf16 v34, v74, v6, v34
v_dot2_f32_bf16 v35, v78, v6, v35
v_dot2_f32_bf16 v34, v75, v7, v34
v_dot2_f32_bf16 v35, v79, v7, v35
s_waitcnt vmcnt(26)
v_dot2_f32_bf16 v36, v80, v4, 0
v_dot2_f32_bf16 v37, v84, v4, 0
v_dot2_f32_bf16 v36, v81, v5, v36
v_dot2_f32_bf16 v37, v85, v5, v37
v_dot2_f32_bf16 v36, v82, v6, v36
v_dot2_f32_bf16 v37, v86, v6, v37
v_dot2_f32_bf16 v36, v83, v7, v36
v_dot2_f32_bf16 v37, v87, v7, v37
s_waitcnt vmcnt(24)
v_dot2_f32_bf16 v38, v88, v4, 0
v_dot2_f32_bf16 v39, v92, v4, 0
v_dot2_f32_bf16 v38, v89, v5, v38
v_dot2_f32_bf16 v39, v93, v5, v39
v_dot2_f32_bf16 v38, v90, v6, v38
v_dot2_f32_bf16 v39, v94, v6, v39
v_dot2_f32_bf16 v38, v91, v7, v38
v_dot2_f32_bf16 v39, v95, v7, v39
s_waitcnt vmcnt(22)
v_dot2_f32_bf16 v40, v96, v4, 0
v_dot2_f32_bf16 v41, v100, v4, 0
v_dot2_f32_bf16 v40, v97, v5, v40
v_dot2_f32_bf16 v41, v101, v5, v41
v_dot2_f32_bf16 v40, v98, v6, v40
v_dot2_f32_bf16 v41, v102, v6, v41
v_dot2_f32_bf16 v40, v99, v7, v40
v_dot2_f32_bf16 v41, v103, v7, v41
s_waitcnt vmcnt(20)
v_dot2_f32_bf16 v42, v104, v4, 0
v_dot2_f32_bf16 v43, v108, v4, 0
v_dot2_f32_bf16 v42, v105, v5, v42
v_dot2_f32_bf16 v43, v109, v5, v43
v_dot2_f32_bf16 v42, v106, v6, v42
v_dot2_f32_bf16 v43, v110, v6, v43
v_dot2_f32_bf16 v42, v107, v7, v42
v_dot2_f32_bf16 v43, v111, v7, v43
s_waitcnt vmcnt(18)
v_dot2_f32_bf16 v44, v112, v4, 0
v_dot2_f32_bf16 v45, v116, v4, 0
v_dot2_f32_bf16 v44, v113, v5, v44
v_dot2_f32_bf16 v45, v117, v5, v45
v_dot2_f32_bf16 v44, v114, v6, v44
v_dot2_f32_bf16 v45, v118, v6, v45
v_dot2_f32_bf16 v44, v115, v7, v44
v_dot2_f32_bf16 v45, v119, v7, v45
s_waitcnt vmcnt(16)
v_dot2_f32_bf16 v46, v120, v4, 0
v_dot2_f32_bf16 v47, v124, v4, 0
v_dot2_f32_bf16 v46, v121, v5, v46
v_dot2_f32_bf16 v47, v125, v5, v47
v_dot2_f32_bf16 v46, v122, v6, v46
v_dot2_f32_bf16 v47, v126, v6, v47
v_dot2_f32_bf16 v46, v123, v7, v46
v_dot2_f32_bf16 v47, v127, v7, v47
buffer_load_dwordx4 v[64:67], v2, s[40:43], s92 offen offset:0 nt
v_add_f32_dpp v32, v32, v32 row_ror:8 row_mask:0xf bank_mask:0x3
v_add_f32_dpp v33, v33, v33 row_ror:8 row_mask:0xf bank_mask:0x3
v_add_f32_dpp v34, v34, v34 row_ror:8 row_mask:0xf bank_mask:0x3
buffer_load_dwordx4 v[68:71], v3, s[40:43], s92 offen offset:0 nt
v_add_f32_dpp v35, v35, v35 row_ror:8 row_mask:0xf bank_mask:0x3
v_add_f32_dpp v36, v36, v36 row_ror:8 row_mask:0xf bank_mask:0x3
v_add_f32_dpp v37, v37, v37 row_ror:8 row_mask:0xf bank_mask:0x3
buffer_load_dwordx4 v[72:75], v2, s[40:43], s92 offen offset:512 nt
v_add_f32_dpp v38, v38, v38 row_ror:8 row_mask:0xf bank_mask:0x3
v_add_f32_dpp v39, v39, v39 row_ror:8 row_mask:0xf bank_mask:0x3
v_add_f32_dpp v32, v40, v40 row_ror:8 row_mask:0xf bank_mask:0xc
buffer_load_dwordx4 v[76:79], v3, s[40:43], s92 offen offset:512 nt
v_add_f32_dpp v33, v41, v41 row_ror:8 row_mask:0xf bank_mask:0xc
v_add_f32_dpp v34, v42, v42 row_ror:8 row_mask:0xf bank_mask:0xc
v_add_f32_dpp v35, v43, v43 row_ror:8 row_mask:0xf bank_mask:0xc
buffer_load_dwordx4 v[80:83], v2, s[40:43], s92 offen offset:2048 nt
v_add_f32_dpp v36, v44, v44 row_ror:8 row_mask:0xf bank_mask:0xc
v_add_f32_dpp v37, v45, v45 row_ror:8 row_mask:0xf bank_mask:0xc
v_add_f32_dpp v38, v46, v46 row_ror:8 row_mask:0xf bank_mask:0xc
buffer_load_dwordx4 v[84:87], v3, s[40:43], s92 offen offset:2048 nt
v_add_f32_dpp v39, v47, v47 row_ror:8 row_mask:0xf bank_mask:0xc
v_add_f32_dpp v32, v32, v32 row_shl:4 row_mask:0xf bank_mask:0x5
v_add_f32_dpp v33, v33, v33 row_shl:4 row_mask:0xf bank_mask:0x5
buffer_load_dwordx4 v[88:91], v2, s[40:43], s92 offen offset:2560 nt
v_add_f32_dpp v34, v34, v34 row_shl:4 row_mask:0xf bank_mask:0x5
v_add_f32_dpp v35, v35, v35 row_shl:4 row_mask:0xf bank_mask:0x5
v_add_f32_dpp v32, v36, v36 row_shr:4 row_mask:0xf bank_mask:0xa
buffer_load_dwordx4 v[92:95], v3, s[40:43], s92 offen offset:2560 nt
v_add_f32_dpp v33, v37, v37 row_shr:4 row_mask:0xf bank_mask:0xa
v_add_f32_dpp v34, v38, v38 row_shr:4 row_mask:0xf bank_mask:0xa
v_add_f32_dpp v35, v39, v39 row_shr:4 row_mask:0xf bank_mask:0xa
buffer_load_dwordx4 v[96:99], v2, s[40:43], s92 offen offset:1024 nt
v_add_f32_dpp v32, v32, v32 quad_perm:[2,3,0,1] row_mask:0xf bank_mask:0xf
v_add_f32_dpp v33, v33, v33 quad_perm:[2,3,0,1] row_mask:0xf bank_mask:0xf
v_add_f32_dpp v34, v34, v34 quad_perm:[2,3,0,1] row_mask:0xf bank_mask:0xf
buffer_load_dwordx4 v[100:103], v3, s[40:43], s92 offen offset:1024 nt
v_add_f32_dpp v35, v35, v35 quad_perm:[2,3,0,1] row_mask:0xf bank_mask:0xf
v_cndmask_b32 v32, v32, v34, s[84:85]
v_cndmask_b32 v33, v33, v35, s[84:85]
buffer_load_dwordx4 v[104:107], v2, s[40:43], s92 offen offset:1536 nt
v_add_f32_dpp v32, v32, v32 quad_perm:[1,0,3,2] row_mask:0xf bank_mask:0xf
v_add_f32_dpp v33, v33, v33 quad_perm:[1,0,3,2] row_mask:0xf bank_mask:0xf
v_cndmask_b32 v32, v32, v33, s[86:87]
buffer_load_dwordx4 v[108:111], v3, s[40:43], s92 offen offset:1536 nt
v_mov_b32 v33, v32
s_nop 1
v_permlane16_swap_b32 v32, v33
v_add_f32 v32, v32, v33
buffer_load_dwordx4 v[112:115], v2, s[40:43], s92 offen offset:3072 nt
v_mov_b32 v33, v32
s_nop 1
v_permlane32_swap_b32 v32, v33
v_cvt_pk_bf16_f32 v54, v32, v33
buffer_load_dwordx4 v[116:119], v3, s[40:43], s92 offen offset:3072 nt
ds_write_b32 v8, v54
v_add_u32 v8, 64, v8
buffer_load_dwordx4 v[120:123], v2, s[40:43], s92 offen offset:3584 nt
buffer_load_dwordx4 v[124:127], v3, s[40:43], s92 offen offset:3584 nt
s_xor_b32 s92, s92, 0x202000
s_waitcnt vmcnt(30)
v_dot2_f32_bf16 v32, v128, v4, 0
v_dot2_f32_bf16 v33, v132, v4, 0
v_dot2_f32_bf16 v32, v129, v5, v32
v_dot2_f32_bf16 v33, v133, v5, v33
v_dot2_f32_bf16 v32, v130, v6, v32
v_dot2_f32_bf16 v33, v134, v6, v33
v_dot2_f32_bf16 v32, v131, v7, v32
v_dot2_f32_bf16 v33, v135, v7, v33
s_waitcnt vmcnt(28)
v_dot2_f32_bf16 v34, v136, v4, 0
v_dot2_f32_bf16 v35, v140, v4, 0
v_dot2_f32_bf16 v34, v137, v5, v34
v_dot2_f32_bf16 v35, v141, v5, v35
v_dot2_f32_bf16 v34, v138, v6, v34
v_dot2_f32_bf16 v35, v142, v6, v35
v_dot2_f32_bf16 v34, v139, v7, v34
v_dot2_f32_bf16 v35, v143, v7, v35
s_waitcnt vmcnt(26)
v_dot2_f32_bf16 v36, v144, v4, 0
v_dot2_f32_bf16 v37, v148, v4, 0
v_dot2_f32_bf16 v36, v145, v5, v36
v_dot2_f32_bf16 v37, v149, v5, v37
v_dot2_f32_bf16 v36, v146, v6, v36
v_dot2_f32_bf16 v37, v150, v6, v37
v_dot2_f32_bf16 v36, v147, v7, v36
v_dot2_f32_bf16 v37, v151, v7, v37
s_waitcnt vmcnt(24)
v_dot2_f32_bf16 v38, v152, v4, 0
v_dot2_f32_bf16 v39, v156, v4, 0
v_dot2_f32_bf16 v38, v153, v5, v38
v_dot2_f32_bf16 v39, v157, v5, v39
v_dot2_f32_bf16 v38, v154, v6, v38
v_dot2_f32_bf16 v39, v158, v6, v39
v_dot2_f32_bf16 v38, v155, v7, v38
v_dot2_f32_bf16 v39, v159, v7, v39
s_waitcnt vmcnt(22)
v_dot2_f32_bf16 v40, v160, v4, 0
v_dot2_f32_bf16 v41, v164, v4, 0
v_dot2_f32_bf16 v40, v161, v5, v40
v_dot2_f32_bf16 v41, v165, v5, v41
v_dot2_f32_bf16 v40, v162, v6, v40
v_dot2_f32_bf16 v41, v166, v6, v41
v_dot2_f32_bf16 v40, v163, v7, v40
v_dot2_f32_bf16 v41, v167, v7, v41
s_waitcnt vmcnt(20)
v_dot2_f32_bf16 v42, v168, v4, 0
v_dot2_f32_bf16 v43, v172, v4, 0
v_dot2_f32_bf16 v42, v169, v5, v42
v_dot2_f32_bf16 v43, v173, v5, v43
v_dot2_f32_bf16 v42, v170, v6, v42
v_dot2_f32_bf16 v43, v174, v6, v43
v_dot2_f32_bf16 v42, v171, v7, v42
v_dot2_f32_bf16 v43, v175, v7, v43
s_waitcnt vmcnt(18)
v_dot2_f32_bf16 v44, v176, v4, 0
v_dot2_f32_bf16 v45, v180, v4, 0
v_dot2_f32_bf16 v44, v177, v5, v44
v_dot2_f32_bf16 v45, v181, v5, v45
v_dot2_f32_bf16 v44, v178, v6, v44
v_dot2_f32_bf16 v45, v182, v6, v45
v_dot2_f32_bf16 v44, v179, v7, v44
v_dot2_f32_bf16 v45, v183, v7, v45
s_waitcnt vmcnt(16)
v_dot2_f32_bf16 v46, v184, v4, 0
v_dot2_f32_bf16 v47, v188, v4, 0
v_dot2_f32_bf16 v46, v185, v5, v46
v_dot2_f32_bf16 v47, v189, v5, v47
v_dot2_f32_bf16 v46, v186, v6, v46
v_dot2_f32_bf16 v47, v190, v6, v47
v_dot2_f32_bf16 v46, v187, v7, v46
v_dot2_f32_bf16 v47, v191, v7, v47
buffer_load_dwordx4 v[128:131], v2, s[40:43], s92 offen offset:0 nt
v_add_f32_dpp v32, v32, v32 row_ror:8 row_mask:0xf bank_mask:0x3
v_add_f32_dpp v33, v33, v33 row_ror:8 row_mask:0xf bank_mask:0x3
v_add_f32_dpp v34, v34, v34 row_ror:8 row_mask:0xf bank_mask:0x3
buffer_load_dwordx4 v[132:135], v3, s[40:43], s92 offen offset:0 nt
v_add_f32_dpp v35, v35, v35 row_ror:8 row_mask:0xf bank_mask:0x3
v_add_f32_dpp v36, v36, v36 row_ror:8 row_mask:0xf bank_mask:0x3
v_add_f32_dpp v37, v37, v37 row_ror:8 row_mask:0xf bank_mask:0x3
buffer_load_dwordx4 v[136:139], v2, s[40:43], s92 offen offset:512 nt
v_add_f32_dpp v38, v38, v38 row_ror:8 row_mask:0xf bank_mask:0x3
v_add_f32_dpp v39, v39, v39 row_ror:8 row_mask:0xf bank_mask:0x3
v_add_f32_dpp v32, v40, v40 row_ror:8 row_mask:0xf bank_mask:0xc
buffer_load_dwordx4 v[140:143], v3, s[40:43], s92 offen offset:512 nt
v_add_f32_dpp v33, v41, v41 row_ror:8 row_mask:0xf bank_mask:0xc
v_add_f32_dpp v34, v42, v42 row_ror:8 row_mask:0xf bank_mask:0xc
v_add_f32_dpp v35, v43, v43 row_ror:8 row_mask:0xf bank_mask:0xc
buffer_load_dwordx4 v[144:147], v2, s[40:43], s92 offen offset:2048 nt
v_add_f32_dpp v36, v44, v44 row_ror:8 row_mask:0xf bank_mask:0xc
v_add_f32_dpp v37, v45, v45 row_ror:8 row_mask:0xf bank_mask:0xc
v_add_f32_dpp v38, v46, v46 row_ror:8 row_mask:0xf bank_mask:0xc
buffer_load_dwordx4 v[148:151], v3, s[40:43], s92 offen offset:2048 nt
v_add_f32_dpp v39, v47, v47 row_ror:8 row_mask:0xf bank_mask:0xc
v_add_f32_dpp v32, v32, v32 row_shl:4 row_mask:0xf bank_mask:0x5
v_add_f32_dpp v33, v33, v33 row_shl:4 row_mask:0xf bank_mask:0x5
buffer_load_dwordx4 v[152:155], v2, s[40:43], s92 offen offset:2560 nt
v_add_f32_dpp v34, v34, v34 row_shl:4 row_mask:0xf bank_mask:0x5
v_add_f32_dpp v35, v35, v35 row_shl:4 row_mask:0xf bank_mask:0x5
v_add_f32_dpp v32, v36, v36 row_shr:4 row_mask:0xf bank_mask:0xa
buffer_load_dwordx4 v[156:159], v3, s[40:43], s92 offen offset:2560 nt
v_add_f32_dpp v33, v37, v37 row_shr:4 row_mask:0xf bank_mask:0xa
v_add_f32_dpp v34, v38, v38 row_shr:4 row_mask:0xf bank_mask:0xa
v_add_f32_dpp v35, v39, v39 row_shr:4 row_mask:0xf bank_mask:0xa
buffer_load_dwordx4 v[160:163], v2, s[40:43], s92 offen offset:1024 nt
v_add_f32_dpp v32, v32, v32 quad_perm:[2,3,0,1] row_mask:0xf bank_mask:0xf
v_add_f32_dpp v33, v33, v33 quad_perm:[2,3,0,1] row_mask:0xf bank_mask:0xf
v_add_f32_dpp v34, v34, v34 quad_perm:[2,3,0,1] row_mask:0xf bank_mask:0xf
buffer_load_dwordx4 v[164:167], v3, s[40:43], s92 offen offset:1024 nt
v_add_f32_dpp v35, v35, v35 quad_perm:[2,3,0,1] row_mask:0xf bank_mask:0xf
v_cndmask_b32 v32, v32, v34, s[84:85]
v_cndmask_b32 v33, v33, v35, s[84:85]
buffer_load_dwordx4 v[168:171], v2, s[40:43], s92 offen offset:1536 nt
v_add_f32_dpp v32, v32, v32 quad_perm:[1,0,3,2] row_mask:0xf bank_mask:0xf
v_add_f32_dpp v33, v33, v33 quad_perm:[1,0,3,2] row_mask:0xf bank_mask:0xf
v_cndmask_b32 v32, v32, v33, s[86:87]
buffer_load_dwordx4 v[172:175], v3, s[40:43], s92 offen offset:1536 nt
v_mov_b32 v33, v32
s_nop 1
v_permlane16_swap_b32 v32, v33
v_add_f32 v32, v32, v33
buffer_load_dwordx4 v[176:179], v2, s[40:43], s92 offen offset:3072 nt
v_mov_b32 v33, v32
s_nop 1
v_permlane32_swap_b32 v32, v33
v_cvt_pk_bf16_f32 v54, v32, v33
buffer_load_dwordx4 v[180:183], v3, s[40:43], s92 offen offset:3072 nt
ds_write_b32 v8, v54
v_add_u32 v8, 64, v8
buffer_load_dwordx4 v[184:187], v2, s[40:43], s92 offen offset:3584 nt
buffer_load_dwordx4 v[188:191], v3, s[40:43], s92 offen offset:3584 nt
s_cmp_lg_u32 s94, 12
s_cbranch_scc1 k_next
s_waitcnt lgkmcnt(0)
s_barrier
k_next:
s_add_u32 s94, s94, 2
s_cmp_lt_u32 s94, 64
s_cbranch_scc1 k_loop
s_mov_b32 s92, s91
s_waitcnt vmcnt(30)
v_dot2_f32_bf16 v32, v64, v4, 0
v_dot2_f32_bf16 v33, v68, v4, 0
v_dot2_f32_bf16 v32, v65, v5, v32
v_dot2_f32_bf16 v33, v69, v5, v33
v_dot2_f32_bf16 v32, v66, v6, v32
v_dot2_f32_bf16 v33, v70, v6, v33
v_dot2_f32_bf16 v32, v67, v7, v32
v_dot2_f32_bf16 v33, v71, v7, v33
s_waitcnt vmcnt(28)
v_dot2_f32_bf16 v34, v72, v4, 0
v_dot2_f32_bf16 v35, v76, v4, 0
v_dot2_f32_bf16 v34, v73, v5, v34
v_dot2_f32_bf16 v35, v77, v5, v35
v_dot2_f32_bf16 v34, v74, v6, v34
v_dot2_f32_bf16 v35, v78, v6, v35
v_dot2_f32_bf16 v34, v75, v7, v34
v_dot2_f32_bf16 v35, v79, v7, v35
s_waitcnt vmcnt(26)
v_dot2_f32_bf16 v36, v80, v4, 0
v_dot2_f32_bf16 v37, v84, v4, 0
v_dot2_f32_bf16 v36, v81, v5, v36
v_dot2_f32_bf16 v37, v85, v5, v37
v_dot2_f32_bf16 v36, v82, v6, v36
v_dot2_f32_bf16 v37, v86, v6, v37
v_dot2_f32_bf16 v36, v83, v7, v36
v_dot2_f32_bf16 v37, v87, v7, v37
s_waitcnt vmcnt(24)
v_dot2_f32_bf16 v38, v88, v4, 0
v_dot2_f32_bf16 v39, v92, v4, 0
v_dot2_f32_bf16 v38, v89, v5, v38
v_dot2_f32_bf16 v39, v93, v5, v39
v_dot2_f32_bf16 v38, v90, v6, v38
v_dot2_f32_bf16 v39, v94, v6, v39
v_dot2_f32_bf16 v38, v91, v7, v38
v_dot2_f32_bf16 v39, v95, v7, v39
s_waitcnt vmcnt(22)
v_dot2_f32_bf16 v40, v96, v4, 0
v_dot2_f32_bf16 v41, v100, v4, 0
v_dot2_f32_bf16 v40, v97, v5, v40
v_dot2_f32_bf16 v41, v101, v5, v41
v_dot2_f32_bf16 v40, v98, v6, v40
v_dot2_f32_bf16 v41, v102, v6, v41
v_dot2_f32_bf16 v40, v99, v7, v40
v_dot2_f32_bf16 v41, v103, v7, v41
s_waitcnt vmcnt(20)
v_dot2_f32_bf16 v42, v104, v4, 0
v_dot2_f32_bf16 v43, v108, v4, 0
v_dot2_f32_bf16 v42, v105, v5, v42
v_dot2_f32_bf16 v43, v109, v5, v43
v_dot2_f32_bf16 v42, v106, v6, v42
v_dot2_f32_bf16 v43, v110, v6, v43
v_dot2_f32_bf16 v42, v107, v7, v42
v_dot2_f32_bf16 v43, v111, v7, v43
s_waitcnt vmcnt(18)
v_dot2_f32_bf16 v44, v112, v4, 0
v_dot2_f32_bf16 v45, v116, v4, 0
v_dot2_f32_bf16 v44, v113, v5, v44
v_dot2_f32_bf16 v45, v117, v5, v45
v_dot2_f32_bf16 v44, v114, v6, v44
v_dot2_f32_bf16 v45, v118, v6, v45
v_dot2_f32_bf16 v44, v115, v7, v44
v_dot2_f32_bf16 v45, v119, v7, v45
s_waitcnt vmcnt(16)
v_dot2_f32_bf16 v46, v120, v4, 0
v_dot2_f32_bf16 v47, v124, v4, 0
v_dot2_f32_bf16 v46, v121, v5, v46
v_dot2_f32_bf16 v47, v125, v5, v47
v_dot2_f32_bf16 v46, v122, v6, v46
v_dot2_f32_bf16 v47, v126, v6, v47
v_dot2_f32_bf16 v46, v123, v7, v46
v_dot2_f32_bf16 v47, v127, v7, v47
buffer_load_dwordx4 v[64:67], v2, s[44:47], s92 offen offset:0 nt
v_add_f32_dpp v32, v32, v32 row_ror:8 row_mask:0xf bank_mask:0x3
v_add_f32_dpp v33, v33, v33 row_ror:8 row_mask:0xf bank_mask:0x3
v_add_f32_dpp v34, v34, v34 row_ror:8 row_mask:0xf bank_mask:0x3
buffer_load_dwordx4 v[68:71], v3, s[44:47], s92 offen offset:0 nt
v_add_f32_dpp v35, v35, v35 row_ror:8 row_mask:0xf bank_mask:0x3
v_add_f32_dpp v36, v36, v36 row_ror:8 row_mask:0xf bank_mask:0x3
v_add_f32_dpp v37, v37, v37 row_ror:8 row_mask:0xf bank_mask:0x3
buffer_load_dwordx4 v[72:75], v2, s[44:47], s92 offen offset:512 nt
v_add_f32_dpp v38, v38, v38 row_ror:8 row_mask:0xf bank_mask:0x3
v_add_f32_dpp v39, v39, v39 row_ror:8 row_mask:0xf bank_mask:0x3
v_add_f32_dpp v32, v40, v40 row_ror:8 row_mask:0xf bank_mask:0xc
buffer_load_dwordx4 v[76:79], v3, s[44:47], s92 offen offset:512 nt
v_add_f32_dpp v33, v41, v41 row_ror:8 row_mask:0xf bank_mask:0xc
v_add_f32_dpp v34, v42, v42 row_ror:8 row_mask:0xf bank_mask:0xc
v_add_f32_dpp v35, v43, v43 row_ror:8 row_mask:0xf bank_mask:0xc
buffer_load_dwordx4 v[80:83], v2, s[44:47], s92 offen offset:2048 nt
v_add_f32_dpp v36, v44, v44 row_ror:8 row_mask:0xf bank_mask:0xc
v_add_f32_dpp v37, v45, v45 row_ror:8 row_mask:0xf bank_mask:0xc
v_add_f32_dpp v38, v46, v46 row_ror:8 row_mask:0xf bank_mask:0xc
buffer_load_dwordx4 v[84:87], v3, s[44:47], s92 offen offset:2048 nt
v_add_f32_dpp v39, v47, v47 row_ror:8 row_mask:0xf bank_mask:0xc
v_add_f32_dpp v32, v32, v32 row_shl:4 row_mask:0xf bank_mask:0x5
v_add_f32_dpp v33, v33, v33 row_shl:4 row_mask:0xf bank_mask:0x5
buffer_load_dwordx4 v[88:91], v2, s[44:47], s92 offen offset:2560 nt
v_add_f32_dpp v34, v34, v34 row_shl:4 row_mask:0xf bank_mask:0x5
v_add_f32_dpp v35, v35, v35 row_shl:4 row_mask:0xf bank_mask:0x5
v_add_f32_dpp v32, v36, v36 row_shr:4 row_mask:0xf bank_mask:0xa
buffer_load_dwordx4 v[92:95], v3, s[44:47], s92 offen offset:2560 nt
v_add_f32_dpp v33, v37, v37 row_shr:4 row_mask:0xf bank_mask:0xa
v_add_f32_dpp v34, v38, v38 row_shr:4 row_mask:0xf bank_mask:0xa
v_add_f32_dpp v35, v39, v39 row_shr:4 row_mask:0xf bank_mask:0xa
buffer_load_dwordx4 v[96:99], v2, s[44:47], s92 offen offset:1024 nt
v_add_f32_dpp v32, v32, v32 quad_perm:[2,3,0,1] row_mask:0xf bank_mask:0xf
v_add_f32_dpp v33, v33, v33 quad_perm:[2,3,0,1] row_mask:0xf bank_mask:0xf
v_add_f32_dpp v34, v34, v34 quad_perm:[2,3,0,1] row_mask:0xf bank_mask:0xf
buffer_load_dwordx4 v[100:103], v3, s[44:47], s92 offen offset:1024 nt
v_add_f32_dpp v35, v35, v35 quad_perm:[2,3,0,1] row_mask:0xf bank_mask:0xf
v_cndmask_b32 v32, v32, v34, s[84:85]
v_cndmask_b32 v33, v33, v35, s[84:85]
buffer_load_dwordx4 v[104:107], v2, s[44:47], s92 offen offset:1536 nt
v_add_f32_dpp v32, v32, v32 quad_perm:[1,0,3,2] row_mask:0xf bank_mask:0xf
v_add_f32_dpp v33, v33, v33 quad_perm:[1,0,3,2] row_mask:0xf bank_mask:0xf
v_cndmask_b32 v32, v32, v33, s[86:87]
buffer_load_dwordx4 v[108:111], v3, s[44:47], s92 offen offset:1536 nt
v_mov_b32 v33, v32
s_nop 1
v_permlane16_swap_b32 v32, v33
v_add_f32 v32, v32, v33
buffer_load_dwordx4 v[112:115], v2, s[44:47], s92 offen offset:3072 nt
v_mov_b32 v33, v32
s_nop 1
v_permlane32_swap_b32 v32, v33
v_cvt_pk_bf16_f32 v54, v32, v33
buffer_load_dwordx4 v[116:119], v3, s[44:47], s92 offen offset:3072 nt
ds_write_b32 v8, v54
v_add_u32 v8, 64, v8
buffer_load_dwordx4 v[120:123], v2, s[44:47], s92 offen offset:3584 nt
buffer_load_dwordx4 v[124:127], v3, s[44:47], s92 offen offset:3584 nt
s_xor_b32 s92, s92, 0x202000
s_waitcnt vmcnt(30)
v_dot2_f32_bf16 v32, v128, v4, 0
v_dot2_f32_bf16 v33, v132, v4, 0
v_dot2_f32_bf16 v32, v129, v5, v32
v_dot2_f32_bf16 v33, v133, v5, v33
v_dot2_f32_bf16 v32, v130, v6, v32
v_dot2_f32_bf16 v33, v134, v6, v33
v_dot2_f32_bf16 v32, v131, v7, v32
v_dot2_f32_bf16 v33, v135, v7, v33
s_waitcnt vmcnt(28)
v_dot2_f32_bf16 v34, v136, v4, 0
v_dot2_f32_bf16 v35, v140, v4, 0
v_dot2_f32_bf16 v34, v137, v5, v34
v_dot2_f32_bf16 v35, v141, v5, v35
v_dot2_f32_bf16 v34, v138, v6, v34
v_dot2_f32_bf16 v35, v142, v6, v35
v_dot2_f32_bf16 v34, v139, v7, v34
v_dot2_f32_bf16 v35, v143, v7, v35
s_waitcnt vmcnt(26)
v_dot2_f32_bf16 v36, v144, v4, 0
v_dot2_f32_bf16 v37, v148, v4, 0
v_dot2_f32_bf16 v36, v145, v5, v36
v_dot2_f32_bf16 v37, v149, v5, v37
v_dot2_f32_bf16 v36, v146, v6, v36
v_dot2_f32_bf16 v37, v150, v6, v37
v_dot2_f32_bf16 v36, v147, v7, v36
v_dot2_f32_bf16 v37, v151, v7, v37
s_waitcnt vmcnt(24)
v_dot2_f32_bf16 v38, v152, v4, 0
v_dot2_f32_bf16 v39, v156, v4, 0
v_dot2_f32_bf16 v38, v153, v5, v38
v_dot2_f32_bf16 v39, v157, v5, v39
v_dot2_f32_bf16 v38, v154, v6, v38
v_dot2_f32_bf16 v39, v158, v6, v39
v_dot2_f32_bf16 v38, v155, v7, v38
v_dot2_f32_bf16 v39, v159, v7, v39
s_waitcnt vmcnt(22)
v_dot2_f32_bf16 v40, v160, v4, 0
v_dot2_f32_bf16 v41, v164, v4, 0
v_dot2_f32_bf16 v40, v161, v5, v40
v_dot2_f32_bf16 v41, v165, v5, v41
v_dot2_f32_bf16 v40, v162, v6, v40
v_dot2_f32_bf16 v41, v166, v6, v41
v_dot2_f32_bf16 v40, v163, v7, v40
v_dot2_f32_bf16 v41, v167, v7, v41
s_waitcnt vmcnt(20)
v_dot2_f32_bf16 v42, v168, v4, 0
v_dot2_f32_bf16 v43, v172, v4, 0
v_dot2_f32_bf16 v42, v169, v5, v42
v_dot2_f32_bf16 v43, v173, v5, v43
v_dot2_f32_bf16 v42, v170, v6, v42
v_dot2_f32_bf16 v43, v174, v6, v43
v_dot2_f32_bf16 v42, v171, v7, v42
v_dot2_f32_bf16 v43, v175, v7, v43
s_waitcnt vmcnt(18)
v_dot2_f32_bf16 v44, v176, v4, 0
v_dot2_f32_bf16 v45, v180, v4, 0
v_dot2_f32_bf16 v44, v177, v5, v44
v_dot2_f32_bf16 v45, v181, v5, v45
v_dot2_f32_bf16 v44, v178, v6, v44
v_dot2_f32_bf16 v45, v182, v6, v45
v_dot2_f32_bf16 v44, v179, v7, v44
v_dot2_f32_bf16 v45, v183, v7, v45
s_waitcnt vmcnt(16)
v_dot2_f32_bf16 v46, v184, v4, 0
v_dot2_f32_bf16 v47, v188, v4, 0
v_dot2_f32_bf16 v46, v185, v5, v46
v_dot2_f32_bf16 v47, v189, v5, v47
v_dot2_f32_bf16 v46, v186, v6, v46
v_dot2_f32_bf16 v47, v190, v6, v47
v_dot2_f32_bf16 v46, v187, v7, v46
v_dot2_f32_bf16 v47, v191, v7, v47
buffer_load_dwordx4 v[128:131], v2, s[44:47], s92 offen offset:0 nt
v_add_f32_dpp v32, v32, v32 row_ror:8 row_mask:0xf bank_mask:0x3
v_add_f32_dpp v33, v33, v33 row_ror:8 row_mask:0xf bank_mask:0x3
v_add_f32_dpp v34, v34, v34 row_ror:8 row_mask:0xf bank_mask:0x3
buffer_load_dwordx4 v[132:135], v3, s[44:47], s92 offen offset:0 nt
v_add_f32_dpp v35, v35, v35 row_ror:8 row_mask:0xf bank_mask:0x3
v_add_f32_dpp v36, v36, v36 row_ror:8 row_mask:0xf bank_mask:0x3
v_add_f32_dpp v37, v37, v37 row_ror:8 row_mask:0xf bank_mask:0x3
buffer_load_dwordx4 v[136:139], v2, s[44:47], s92 offen offset:512 nt
v_add_f32_dpp v38, v38, v38 row_ror:8 row_mask:0xf bank_mask:0x3
v_add_f32_dpp v39, v39, v39 row_ror:8 row_mask:0xf bank_mask:0x3
v_add_f32_dpp v32, v40, v40 row_ror:8 row_mask:0xf bank_mask:0xc
buffer_load_dwordx4 v[140:143], v3, s[44:47], s92 offen offset:512 nt
v_add_f32_dpp v33, v41, v41 row_ror:8 row_mask:0xf bank_mask:0xc
v_add_f32_dpp v34, v42, v42 row_ror:8 row_mask:0xf bank_mask:0xc
v_add_f32_dpp v35, v43, v43 row_ror:8 row_mask:0xf bank_mask:0xc
buffer_load_dwordx4 v[144:147], v2, s[44:47], s92 offen offset:2048 nt
v_add_f32_dpp v36, v44, v44 row_ror:8 row_mask:0xf bank_mask:0xc
v_add_f32_dpp v37, v45, v45 row_ror:8 row_mask:0xf bank_mask:0xc
v_add_f32_dpp v38, v46, v46 row_ror:8 row_mask:0xf bank_mask:0xc
buffer_load_dwordx4 v[148:151], v3, s[44:47], s92 offen offset:2048 nt
v_add_f32_dpp v39, v47, v47 row_ror:8 row_mask:0xf bank_mask:0xc
v_add_f32_dpp v32, v32, v32 row_shl:4 row_mask:0xf bank_mask:0x5
v_add_f32_dpp v33, v33, v33 row_shl:4 row_mask:0xf bank_mask:0x5
buffer_load_dwordx4 v[152:155], v2, s[44:47], s92 offen offset:2560 nt
v_add_f32_dpp v34, v34, v34 row_shl:4 row_mask:0xf bank_mask:0x5
v_add_f32_dpp v35, v35, v35 row_shl:4 row_mask:0xf bank_mask:0x5
v_add_f32_dpp v32, v36, v36 row_shr:4 row_mask:0xf bank_mask:0xa
buffer_load_dwordx4 v[156:159], v3, s[44:47], s92 offen offset:2560 nt
v_add_f32_dpp v33, v37, v37 row_shr:4 row_mask:0xf bank_mask:0xa
v_add_f32_dpp v34, v38, v38 row_shr:4 row_mask:0xf bank_mask:0xa
v_add_f32_dpp v35, v39, v39 row_shr:4 row_mask:0xf bank_mask:0xa
buffer_load_dwordx4 v[160:163], v2, s[44:47], s92 offen offset:1024 nt
v_add_f32_dpp v32, v32, v32 quad_perm:[2,3,0,1] row_mask:0xf bank_mask:0xf
v_add_f32_dpp v33, v33, v33 quad_perm:[2,3,0,1] row_mask:0xf bank_mask:0xf
v_add_f32_dpp v34, v34, v34 quad_perm:[2,3,0,1] row_mask:0xf bank_mask:0xf
buffer_load_dwordx4 v[164:167], v3, s[44:47], s92 offen offset:1024 nt
v_add_f32_dpp v35, v35, v35 quad_perm:[2,3,0,1] row_mask:0xf bank_mask:0xf
v_cndmask_b32 v32, v32, v34, s[84:85]
v_cndmask_b32 v33, v33, v35, s[84:85]
buffer_load_dwordx4 v[168:171], v2, s[44:47], s92 offen offset:1536 nt
v_add_f32_dpp v32, v32, v32 quad_perm:[1,0,3,2] row_mask:0xf bank_mask:0xf
v_add_f32_dpp v33, v33, v33 quad_perm:[1,0,3,2] row_mask:0xf bank_mask:0xf
v_cndmask_b32 v32, v32, v33, s[86:87]
buffer_load_dwordx4 v[172:175], v3, s[44:47], s92 offen offset:1536 nt
v_mov_b32 v33, v32
s_nop 1
v_permlane16_swap_b32 v32, v33
v_add_f32 v32, v32, v33
buffer_load_dwordx4 v[176:179], v2, s[44:47], s92 offen offset:3072 nt
v_mov_b32 v33, v32
s_nop 1
v_permlane32_swap_b32 v32, v33
v_cvt_pk_bf16_f32 v54, v32, v33
buffer_load_dwordx4 v[180:183], v3, s[44:47], s92 offen offset:3072 nt
ds_write_b32 v8, v54
v_add_u32 v8, 64, v8
buffer_load_dwordx4 v[184:187], v2, s[44:47], s92 offen offset:3584 nt
buffer_load_dwordx4 v[188:191], v3, s[44:47], s92 offen offset:3584 nt
v_subrev_u32 v8, 4096, v8
s_waitcnt lgkmcnt(0)
s_barrier
s_mov_b32 s94, 2
s_mov_b32 s13, 1
s_mov_b32 s15, 64
s_mov_b32 s14, 64
ds_read_b32 v10, v8
v_add_u32 v8, s14, v8
s_waitcnt lgkmcnt(0)
v_lshlrev_b32 v16, v53, v10
v_and_b32 v16, 0xffff0000, v16
s_nop 1
v_max_f32_dpp v14, v16, v16 row_ror:8 row_mask:0xf bank_mask:0xf
s_nop 1
v_max_f32_dpp v14, v14, v14 row_ror:4 row_mask:0xf bank_mask:0xf
s_nop 1
v_max_f32_dpp v14, v14, v14 row_ror:2 row_mask:0xf bank_mask:0xf
s_nop 1
v_max_f32_dpp v14, v14, v14 row_ror:1 row_mask:0xf bank_mask:0xf
v_mov_b32 v15, v14
s_nop 1
v_permlane32_swap_b32 v14, v15
v_max_f32 v14, v14, v15
v_max_f32 v14, v14, v52
v_sub_f32 v15, v52, v14
v_sub_f32 v16, v16, v14
v_mov_b32 v52, v14
v_mul_f32 v15, s88, v15
v_mul_f32 v16, s88, v16
v_exp_f32 v15, v15
v_exp_f32 v16, v16
s_nop 0
v_cvt_pk_bf16_f32 v13, v16, v16
v_fma_f32 v12, v12, v15, v16
v_mul_f32 v48, v48, v15
v_mul_f32 v49, v49, v15
v_mul_f32 v50, v50, v15
v_mul_f32 v51, v51, v15
v_loop:
s_cmp_eq_u32 s94, 56
s_cbranch_scc1 v_share
s_cmp_eq_u32 s94, 60
s_cselect_b32 s15, 128, s15
s_cmp_lg_u32 s94, 12
s_cbranch_scc1 v_go
s_barrier
v_go:
s_mov_b32 s92, s91
s_bitcmp1_b32 s94, 0
s_cselect_b32 s95, 0x202000, 0
v_and_b32_dpp v24, v13, v20 row_newbcast:0 row_mask:0xf bank_mask:0xf
v_and_b32_dpp v25, v13, v21 row_newbcast:0 row_mask:0xf bank_mask:0xf
v_and_b32_dpp v26, v13, v22 row_newbcast:0 row_mask:0xf bank_mask:0xf
v_and_b32_dpp v27, v13, v23 row_newbcast:0 row_mask:0xf bank_mask:0xf
s_waitcnt vmcnt(31)
s_xor_b32 s92, s92, s95
v_mfma_f32_16x16x32_bf16 v[48:51], v[24:27], v[64:67], v[48:51]
v_and_b32_dpp v28, v13, v20 row_newbcast:1 row_mask:0xf bank_mask:0xf
v_and_b32_dpp v29, v13, v21 row_newbcast:1 row_mask:0xf bank_mask:0xf
v_and_b32_dpp v30, v13, v22 row_newbcast:1 row_mask:0xf bank_mask:0xf
v_and_b32_dpp v31, v13, v23 row_newbcast:1 row_mask:0xf bank_mask:0xf
s_waitcnt vmcnt(30)
s_bitcmp1_b32 s94, 1
v_mfma_f32_16x16x32_bf16 v[48:51], v[28:31], v[68:71], v[48:51]
v_and_b32_dpp v24, v13, v20 row_newbcast:2 row_mask:0xf bank_mask:0xf
v_and_b32_dpp v25, v13, v21 row_newbcast:2 row_mask:0xf bank_mask:0xf
v_and_b32_dpp v26, v13, v22 row_newbcast:2 row_mask:0xf bank_mask:0xf
v_and_b32_dpp v27, v13, v23 row_newbcast:2 row_mask:0xf bank_mask:0xf
s_waitcnt vmcnt(29)
s_cselect_b32 s95, 0x484000, 0
v_mfma_f32_16x16x32_bf16 v[48:51], v[24:27], v[72:75], v[48:51]
v_and_b32_dpp v28, v13, v20 row_newbcast:3 row_mask:0xf bank_mask:0xf
v_and_b32_dpp v29, v13, v21 row_newbcast:3 row_mask:0xf bank_mask:0xf
v_and_b32_dpp v30, v13, v22 row_newbcast:3 row_mask:0xf bank_mask:0xf
v_and_b32_dpp v31, v13, v23 row_newbcast:3 row_mask:0xf bank_mask:0xf
s_waitcnt vmcnt(28)
s_xor_b32 s92, s92, s95
v_mfma_f32_16x16x32_bf16 v[48:51], v[28:31], v[76:79], v[48:51]
v_and_b32_dpp v24, v13, v20 row_newbcast:4 row_mask:0xf bank_mask:0xf
v_and_b32_dpp v25, v13, v21 row_newbcast:4 row_mask:0xf bank_mask:0xf
v_and_b32_dpp v26, v13, v22 row_newbcast:4 row_mask:0xf bank_mask:0xf
v_and_b32_dpp v27, v13, v23 row_newbcast:4 row_mask:0xf bank_mask:0xf
s_waitcnt vmcnt(27)
s_bitcmp1_b32 s94, 2
v_mfma_f32_16x16x32_bf16 v[48:51], v[24:27], v[80:83], v[48:51]
v_and_b32_dpp v28, v13, v20 row_newbcast:5 row_mask:0xf bank_mask:0xf
v_and_b32_dpp v29, v13, v21 row_newbcast:5 row_mask:0xf bank_mask:0xf
v_and_b32_dpp v30, v13, v22 row_newbcast:5 row_mask:0xf bank_mask:0xf
v_and_b32_dpp v31, v13, v23 row_newbcast:5 row_mask:0xf bank_mask:0xf
s_waitcnt vmcnt(26)
s_cselect_b32 s95, 0x901000, 0
v_mfma_f32_16x16x32_bf16 v[48:51], v[28:31], v[84:87], v[48:51]
v_and_b32_dpp v24, v13, v20 row_newbcast:6 row_mask:0xf bank_mask:0xf
v_and_b32_dpp v25, v13, v21 row_newbcast:6 row_mask:0xf bank_mask:0xf
v_and_b32_dpp v26, v13, v22 row_newbcast:6 row_mask:0xf bank_mask:0xf
v_and_b32_dpp v27, v13, v23 row_newbcast:6 row_mask:0xf bank_mask:0xf
s_waitcnt vmcnt(25)
s_xor_b32 s92, s92, s95
v_mfma_f32_16x16x32_bf16 v[48:51], v[24:27], v[88:91], v[48:51]
ds_read_b32 v10, v8
v_add_u32 v8, s15, v8
v_and_b32_dpp v28, v13, v20 row_newbcast:7 row_mask:0xf bank_mask:0xf
v_and_b32_dpp v29, v13, v21 row_newbcast:7 row_mask:0xf bank_mask:0xf
v_and_b32_dpp v30, v13, v22 row_newbcast:7 row_mask:0xf bank_mask:0xf
v_and_b32_dpp v31, v13, v23 row_newbcast:7 row_mask:0xf bank_mask:0xf
s_waitcnt vmcnt(24)
s_bitcmp1_b32 s94, 3
v_mfma_f32_16x16x32_bf16 v[48:51], v[28:31], v[92:95], v[48:51]
v_and_b32_dpp v24, v13, v20 row_newbcast:8 row_mask:0xf bank_mask:0xf
v_and_b32_dpp v25, v13, v21 row_newbcast:8 row_mask:0xf bank_mask:0xf
v_and_b32_dpp v26, v13, v22 row_newbcast:8 row_mask:0xf bank_mask:0xf
v_and_b32_dpp v27, v13, v23 row_newbcast:8 row_mask:0xf bank_mask:0xf
s_waitcnt vmcnt(23)
s_cselect_b32 s95, 0x101000, 0
v_mfma_f32_16x16x32_bf16 v[48:51], v[24:27], v[96:99], v[48:51]
v_and_b32_dpp v28, v13, v20 row_newbcast:9 row_mask:0xf bank_mask:0xf
v_and_b32_dpp v29, v13, v21 row_newbcast:9 row_mask:0xf bank_mask:0xf
v_and_b32_dpp v30, v13, v22 row_newbcast:9 row_mask:0xf bank_mask:0xf
v_and_b32_dpp v31, v13, v23 row_newbcast:9 row_mask:0xf bank_mask:0xf
s_waitcnt vmcnt(22)
s_xor_b32 s92, s92, s95
v_mfma_f32_16x16x32_bf16 v[48:51], v[28:31], v[100:103], v[48:51]
v_and_b32_dpp v24, v13, v20 row_newbcast:10 row_mask:0xf bank_mask:0xf
v_and_b32_dpp v25, v13, v21 row_newbcast:10 row_mask:0xf bank_mask:0xf
v_and_b32_dpp v26, v13, v22 row_newbcast:10 row_mask:0xf bank_mask:0xf
v_and_b32_dpp v27, v13, v23 row_newbcast:10 row_mask:0xf bank_mask:0xf
s_waitcnt vmcnt(21)
s_bitcmp1_b32 s94, 4
v_mfma_f32_16x16x32_bf16 v[48:51], v[24:27], v[104:107], v[48:51]
v_and_b32_dpp v28, v13, v20 row_newbcast:11 row_mask:0xf bank_mask:0xf
v_and_b32_dpp v29, v13, v21 row_newbcast:11 row_mask:0xf bank_mask:0xf
v_and_b32_dpp v30, v13, v22 row_newbcast:11 row_mask:0xf bank_mask:0xf
v_and_b32_dpp v31, v13, v23 row_newbcast:11 row_mask:0xf bank_mask:0xf
s_waitcnt vmcnt(20)
s_cselect_b32 s95, 0x40000, 0
v_mfma_f32_16x16x32_bf16 v[48:51], v[28:31], v[108:111], v[48:51]
v_and_b32_dpp v24, v13, v20 row_newbcast:12 row_mask:0xf bank_mask:0xf
v_and_b32_dpp v25, v13, v21 row_newbcast:12 row_mask:0xf bank_mask:0xf
v_and_b32_dpp v26, v13, v22 row_newbcast:12 row_mask:0xf bank_mask:0xf
v_and_b32_dpp v27, v13, v23 row_newbcast:12 row_mask:0xf bank_mask:0xf
s_waitcnt vmcnt(19)
s_xor_b32 s92, s92, s95
v_mfma_f32_16x16x32_bf16 v[48:51], v[24:27], v[112:115], v[48:51]
v_and_b32_dpp v28, v13, v20 row_newbcast:13 row_mask:0xf bank_mask:0xf
v_and_b32_dpp v29, v13, v21 row_newbcast:13 row_mask:0xf bank_mask:0xf
v_and_b32_dpp v30, v13, v22 row_newbcast:13 row_mask:0xf bank_mask:0xf
v_and_b32_dpp v31, v13, v23 row_newbcast:13 row_mask:0xf bank_mask:0xf
s_waitcnt vmcnt(18)
s_bitcmp1_b32 s94, 5
v_mfma_f32_16x16x32_bf16 v[48:51], v[28:31], v[116:119], v[48:51]
v_and_b32_dpp v24, v13, v20 row_newbcast:14 row_mask:0xf bank_mask:0xf
v_and_b32_dpp v25, v13, v21 row_newbcast:14 row_mask:0xf bank_mask:0xf
v_and_b32_dpp v26, v13, v22 row_newbcast:14 row_mask:0xf bank_mask:0xf
v_and_b32_dpp v27, v13, v23 row_newbcast:14 row_mask:0xf bank_mask:0xf
s_waitcnt vmcnt(17)
s_cselect_b32 s95, 0x20000, 0
v_mfma_f32_16x16x32_bf16 v[48:51], v[24:27], v[120:123], v[48:51]
v_and_b32_dpp v28, v13, v20 row_newbcast:15 row_mask:0xf bank_mask:0xf
v_and_b32_dpp v29, v13, v21 row_newbcast:15 row_mask:0xf bank_mask:0xf
v_and_b32_dpp v30, v13, v22 row_newbcast:15 row_mask:0xf bank_mask:0xf
v_and_b32_dpp v31, v13, v23 row_newbcast:15 row_mask:0xf bank_mask:0xf
s_waitcnt vmcnt(16)
s_xor_b32 s92, s92, s95
v_mfma_f32_16x16x32_bf16 v[48:51], v[28:31], v[124:127], v[48:51]
buffer_load_dwordx4 v[64:67], v2, s[44:47], s92 offen offset:0 nt
s_waitcnt lgkmcnt(0)
v_lshlrev_b32 v16, v53, v10
buffer_load_dwordx4 v[68:71], v3, s[44:47], s92 offen offset:0 nt
v_and_b32 v16, 0xffff0000, v16
s_nop 1
v_max_f32_dpp v14, v16, v16 row_ror:8 row_mask:0xf bank_mask:0xf
buffer_load_dwordx4 v[72:75], v2, s[44:47], s92 offen offset:512 nt
s_nop 0
v_max_f32_dpp v14, v14, v14 row_ror:4 row_mask:0xf bank_mask:0xf
s_nop 1
v_max_f32_dpp v14, v14, v14 row_ror:2 row_mask:0xf bank_mask:0xf
buffer_load_dwordx4 v[76:79], v3, s[44:47], s92 offen offset:512 nt
s_nop 0
v_max_f32_dpp v14, v14, v14 row_ror:1 row_mask:0xf bank_mask:0xf
v_mov_b32 v15, v14
buffer_load_dwordx4 v[80:83], v2, s[44:47], s92 offen offset:2048 nt
s_nop 0
v_permlane32_swap_b32 v14, v15
v_max_f32 v14, v14, v15
buffer_load_dwordx4 v[84:87], v3, s[44:47], s92 offen offset:2048 nt
v_max_f32 v14, v14, v52
v_sub_f32 v15, v52, v14
buffer_load_dwordx4 v[88:91], v2, s[44:47], s92 offen offset:2560 nt
v_sub_f32 v16, v16, v14
v_mov_b32 v52, v14
buffer_load_dwordx4 v[92:95], v3, s[44:47], s92 offen offset:2560 nt
v_mul_f32 v15, s88, v15
v_mul_f32 v16, s88, v16
buffer_load_dwordx4 v[96:99], v2, s[44:47], s92 offen offset:1024 nt
v_exp_f32 v15, v15
v_exp_f32 v16, v16
buffer_load_dwordx4 v[100:103], v3, s[44:47], s92 offen offset:1024 nt
v_cvt_pk_bf16_f32 v13, v16, v16
v_fma_f32 v12, v12, v15, v16
buffer_load_dwordx4 v[104:107], v2, s[44:47], s92 offen offset:1536 nt
v_mul_f32 v48, v48, v15
v_mul_f32 v49, v49, v15
buffer_load_dwordx4 v[108:111], v3, s[44:47], s92 offen offset:1536 nt
v_mul_f32 v50, v50, v15
v_mul_f32 v51, v51, v15
buffer_load_dwordx4 v[112:115], v2, s[44:47], s92 offen offset:3072 nt
buffer_load_dwordx4 v[116:119], v3, s[44:47], s92 offen offset:3072 nt
buffer_load_dwordx4 v[120:123], v2, s[44:47], s92 offen offset:3584 nt
buffer_load_dwordx4 v[124:127], v3, s[44:47], s92 offen offset:3584 nt
s_add_u32 s94, s94, s13
s_mov_b32 s92, s91
s_bitcmp1_b32 s94, 0
s_cselect_b32 s95, 0x202000, 0
v_and_b32_dpp v24, v13, v20 row_newbcast:0 row_mask:0xf bank_mask:0xf
v_and_b32_dpp v25, v13, v21 row_newbcast:0 row_mask:0xf bank_mask:0xf
v_and_b32_dpp v26, v13, v22 row_newbcast:0 row_mask:0xf bank_mask:0xf
v_and_b32_dpp v27, v13, v23 row_newbcast:0 row_mask:0xf bank_mask:0xf
s_waitcnt vmcnt(31)
s_xor_b32 s92, s92, s95
v_mfma_f32_16x16x32_bf16 v[48:51], v[24:27], v[128:131], v[48:51]
v_and_b32_dpp v28, v13, v20 row_newbcast:1 row_mask:0xf bank_mask:0xf
v_and_b32_dpp v29, v13, v21 row_newbcast:1 row_mask:0xf bank_mask:0xf
v_and_b32_dpp v30, v13, v22 row_newbcast:1 row_mask:0xf bank_mask:0xf
v_and_b32_dpp v31, v13, v23 row_newbcast:1 row_mask:0xf bank_mask:0xf
s_waitcnt vmcnt(30)
s_bitcmp1_b32 s94, 1
v_mfma_f32_16x16x32_bf16 v[48:51], v[28:31], v[132:135], v[48:51]
v_and_b32_dpp v24, v13, v20 row_newbcast:2 row_mask:0xf bank_mask:0xf
v_and_b32_dpp v25, v13, v21 row_newbcast:2 row_mask:0xf bank_mask:0xf
v_and_b32_dpp v26, v13, v22 row_newbcast:2 row_mask:0xf bank_mask:0xf
v_and_b32_dpp v27, v13, v23 row_newbcast:2 row_mask:0xf bank_mask:0xf
s_waitcnt vmcnt(29)
s_cselect_b32 s95, 0x484000, 0
v_mfma_f32_16x16x32_bf16 v[48:51], v[24:27], v[136:139], v[48:51]
v_and_b32_dpp v28, v13, v20 row_newbcast:3 row_mask:0xf bank_mask:0xf
v_and_b32_dpp v29, v13, v21 row_newbcast:3 row_mask:0xf bank_mask:0xf
v_and_b32_dpp v30, v13, v22 row_newbcast:3 row_mask:0xf bank_mask:0xf
v_and_b32_dpp v31, v13, v23 row_newbcast:3 row_mask:0xf bank_mask:0xf
s_waitcnt vmcnt(28)
s_xor_b32 s92, s92, s95
v_mfma_f32_16x16x32_bf16 v[48:51], v[28:31], v[140:143], v[48:51]
v_and_b32_dpp v24, v13, v20 row_newbcast:4 row_mask:0xf bank_mask:0xf
v_and_b32_dpp v25, v13, v21 row_newbcast:4 row_mask:0xf bank_mask:0xf
v_and_b32_dpp v26, v13, v22 row_newbcast:4 row_mask:0xf bank_mask:0xf
v_and_b32_dpp v27, v13, v23 row_newbcast:4 row_mask:0xf bank_mask:0xf
s_waitcnt vmcnt(27)
s_bitcmp1_b32 s94, 2
v_mfma_f32_16x16x32_bf16 v[48:51], v[24:27], v[144:147], v[48:51]
v_and_b32_dpp v28, v13, v20 row_newbcast:5 row_mask:0xf bank_mask:0xf
v_and_b32_dpp v29, v13, v21 row_newbcast:5 row_mask:0xf bank_mask:0xf
v_and_b32_dpp v30, v13, v22 row_newbcast:5 row_mask:0xf bank_mask:0xf
v_and_b32_dpp v31, v13, v23 row_newbcast:5 row_mask:0xf bank_mask:0xf
s_waitcnt vmcnt(26)
s_cselect_b32 s95, 0x901000, 0
v_mfma_f32_16x16x32_bf16 v[48:51], v[28:31], v[148:151], v[48:51]
v_and_b32_dpp v24, v13, v20 row_newbcast:6 row_mask:0xf bank_mask:0xf
v_and_b32_dpp v25, v13, v21 row_newbcast:6 row_mask:0xf bank_mask:0xf
v_and_b32_dpp v26, v13, v22 row_newbcast:6 row_mask:0xf bank_mask:0xf
v_and_b32_dpp v27, v13, v23 row_newbcast:6 row_mask:0xf bank_mask:0xf
s_waitcnt vmcnt(25)
s_xor_b32 s92, s92, s95
v_mfma_f32_16x16x32_bf16 v[48:51], v[24:27], v[152:155], v[48:51]
ds_read_b32 v10, v8
v_add_u32 v8, s14, v8
v_and_b32_dpp v28, v13, v20 row_newbcast:7 row_mask:0xf bank_mask:0xf
v_and_b32_dpp v29, v13, v21 row_newbcast:7 row_mask:0xf bank_mask:0xf
v_and_b32_dpp v30, v13, v22 row_newbcast:7 row_mask:0xf bank_mask:0xf
v_and_b32_dpp v31, v13, v23 row_newbcast:7 row_mask:0xf bank_mask:0xf
s_waitcnt vmcnt(24)
s_bitcmp1_b32 s94, 3
v_mfma_f32_16x16x32_bf16 v[48:51], v[28:31], v[156:159], v[48:51]
v_and_b32_dpp v24, v13, v20 row_newbcast:8 row_mask:0xf bank_mask:0xf
v_and_b32_dpp v25, v13, v21 row_newbcast:8 row_mask:0xf bank_mask:0xf
v_and_b32_dpp v26, v13, v22 row_newbcast:8 row_mask:0xf bank_mask:0xf
v_and_b32_dpp v27, v13, v23 row_newbcast:8 row_mask:0xf bank_mask:0xf
s_waitcnt vmcnt(23)
s_cselect_b32 s95, 0x101000, 0
v_mfma_f32_16x16x32_bf16 v[48:51], v[24:27], v[160:163], v[48:51]
v_and_b32_dpp v28, v13, v20 row_newbcast:9 row_mask:0xf bank_mask:0xf
v_and_b32_dpp v29, v13, v21 row_newbcast:9 row_mask:0xf bank_mask:0xf
v_and_b32_dpp v30, v13, v22 row_newbcast:9 row_mask:0xf bank_mask:0xf
v_and_b32_dpp v31, v13, v23 row_newbcast:9 row_mask:0xf bank_mask:0xf
s_waitcnt vmcnt(22)
s_xor_b32 s92, s92, s95
v_mfma_f32_16x16x32_bf16 v[48:51], v[28:31], v[164:167], v[48:51]
v_and_b32_dpp v24, v13, v20 row_newbcast:10 row_mask:0xf bank_mask:0xf
v_and_b32_dpp v25, v13, v21 row_newbcast:10 row_mask:0xf bank_mask:0xf
v_and_b32_dpp v26, v13, v22 row_newbcast:10 row_mask:0xf bank_mask:0xf
v_and_b32_dpp v27, v13, v23 row_newbcast:10 row_mask:0xf bank_mask:0xf
s_waitcnt vmcnt(21)
s_bitcmp1_b32 s94, 4
v_mfma_f32_16x16x32_bf16 v[48:51], v[24:27], v[168:171], v[48:51]
v_and_b32_dpp v28, v13, v20 row_newbcast:11 row_mask:0xf bank_mask:0xf
v_and_b32_dpp v29, v13, v21 row_newbcast:11 row_mask:0xf bank_mask:0xf
v_and_b32_dpp v30, v13, v22 row_newbcast:11 row_mask:0xf bank_mask:0xf
v_and_b32_dpp v31, v13, v23 row_newbcast:11 row_mask:0xf bank_mask:0xf
s_waitcnt vmcnt(20)
s_cselect_b32 s95, 0x40000, 0
v_mfma_f32_16x16x32_bf16 v[48:51], v[28:31], v[172:175], v[48:51]
v_and_b32_dpp v24, v13, v20 row_newbcast:12 row_mask:0xf bank_mask:0xf
v_and_b32_dpp v25, v13, v21 row_newbcast:12 row_mask:0xf bank_mask:0xf
v_and_b32_dpp v26, v13, v22 row_newbcast:12 row_mask:0xf bank_mask:0xf
v_and_b32_dpp v27, v13, v23 row_newbcast:12 row_mask:0xf bank_mask:0xf
s_waitcnt vmcnt(19)
s_xor_b32 s92, s92, s95
v_mfma_f32_16x16x32_bf16 v[48:51], v[24:27], v[176:179], v[48:51]
v_and_b32_dpp v28, v13, v20 row_newbcast:13 row_mask:0xf bank_mask:0xf
v_and_b32_dpp v29, v13, v21 row_newbcast:13 row_mask:0xf bank_mask:0xf
v_and_b32_dpp v30, v13, v22 row_newbcast:13 row_mask:0xf bank_mask:0xf
v_and_b32_dpp v31, v13, v23 row_newbcast:13 row_mask:0xf bank_mask:0xf
s_waitcnt vmcnt(18)
s_bitcmp1_b32 s94, 5
v_mfma_f32_16x16x32_bf16 v[48:51], v[28:31], v[180:183], v[48:51]
v_and_b32_dpp v24, v13, v20 row_newbcast:14 row_mask:0xf bank_mask:0xf
v_and_b32_dpp v25, v13, v21 row_newbcast:14 row_mask:0xf bank_mask:0xf
v_and_b32_dpp v26, v13, v22 row_newbcast:14 row_mask:0xf bank_mask:0xf
v_and_b32_dpp v27, v13, v23 row_newbcast:14 row_mask:0xf bank_mask:0xf
s_waitcnt vmcnt(17)
s_cselect_b32 s95, 0x20000, 0
v_mfma_f32_16x16x32_bf16 v[48:51], v[24:27], v[184:187], v[48:51]
v_and_b32_dpp v28, v13, v20 row_newbcast:15 row_mask:0xf bank_mask:0xf
v_and_b32_dpp v29, v13, v21 row_newbcast:15 row_mask:0xf bank_mask:0xf
v_and_b32_dpp v30, v13, v22 row_newbcast:15 row_mask:0xf bank_mask:0xf
v_and_b32_dpp v31, v13, v23 row_newbcast:15 row_mask:0xf bank_mask:0xf
s_waitcnt vmcnt(16)
s_xor_b32 s92, s92, s95
v_mfma_f32_16x16x32_bf16 v[48:51], v[28:31], v[188:191], v[48:51]
buffer_load_dwordx4 v[128:131], v2, s[44:47], s92 offen offset:0 nt
s_waitcnt lgkmcnt(0)
v_lshlrev_b32 v16, v53, v10
buffer_load_dwordx4 v[132:135], v3, s[44:47], s92 offen offset:0 nt
v_and_b32 v16, 0xffff0000, v16
s_nop 1
v_max_f32_dpp v14, v16, v16 row_ror:8 row_mask:0xf bank_mask:0xf
buffer_load_dwordx4 v[136:139], v2, s[44:47], s92 offen offset:512 nt
s_nop 0
v_max_f32_dpp v14, v14, v14 row_ror:4 row_mask:0xf bank_mask:0xf
s_nop 1
v_max_f32_dpp v14, v14, v14 row_ror:2 row_mask:0xf bank_mask:0xf
buffer_load_dwordx4 v[140:143], v3, s[44:47], s92 offen offset:512 nt
s_nop 0
v_max_f32_dpp v14, v14, v14 row_ror:1 row_mask:0xf bank_mask:0xf
v_mov_b32 v15, v14
buffer_load_dwordx4 v[144:147], v2, s[44:47], s92 offen offset:2048 nt
s_nop 0
v_permlane32_swap_b32 v14, v15
v_max_f32 v14, v14, v15
buffer_load_dwordx4 v[148:151], v3, s[44:47], s92 offen offset:2048 nt
v_max_f32 v14, v14, v52
v_sub_f32 v15, v52, v14
buffer_load_dwordx4 v[152:155], v2, s[44:47], s92 offen offset:2560 nt
v_sub_f32 v16, v16, v14
v_mov_b32 v52, v14
buffer_load_dwordx4 v[156:159], v3, s[44:47], s92 offen offset:2560 nt
v_mul_f32 v15, s88, v15
v_mul_f32 v16, s88, v16
buffer_load_dwordx4 v[160:163], v2, s[44:47], s92 offen offset:1024 nt
v_exp_f32 v15, v15
v_exp_f32 v16, v16
buffer_load_dwordx4 v[164:167], v3, s[44:47], s92 offen offset:1024 nt
v_cvt_pk_bf16_f32 v13, v16, v16
v_fma_f32 v12, v12, v15, v16
buffer_load_dwordx4 v[168:171], v2, s[44:47], s92 offen offset:1536 nt
v_mul_f32 v48, v48, v15
v_mul_f32 v49, v49, v15
buffer_load_dwordx4 v[172:175], v3, s[44:47], s92 offen offset:1536 nt
v_mul_f32 v50, v50, v15
v_mul_f32 v51, v51, v15
buffer_load_dwordx4 v[176:179], v2, s[44:47], s92 offen offset:3072 nt
buffer_load_dwordx4 v[180:183], v3, s[44:47], s92 offen offset:3072 nt
buffer_load_dwordx4 v[184:187], v2, s[44:47], s92 offen offset:3584 nt
buffer_load_dwordx4 v[188:191], v3, s[44:47], s92 offen offset:3584 nt
s_add_u32 s94, s94, s13
s_cmp_lt_u32 s94, 64
s_cbranch_scc1 v_loop
v_fin:
s_mov_b32 s72, 0x7060500
s_mov_b32 s73, 0x7060501
s_mov_b32 s74, 0x7060502
s_mov_b32 s75, 0x7060503
s_mov_b32 s76, 0x0c0c0400
s_mov_b32 s77, 0x04000c0c
s_cmp_eq_u32 s3, 0
s_cbranch_scc1 v_last0
v_and_b32_dpp v24, v13, v20 row_newbcast:0 row_mask:0xf bank_mask:0xf
v_and_b32_dpp v25, v13, v21 row_newbcast:0 row_mask:0xf bank_mask:0xf
v_and_b32_dpp v26, v13, v22 row_newbcast:0 row_mask:0xf bank_mask:0xf
v_and_b32_dpp v27, v13, v23 row_newbcast:0 row_mask:0xf bank_mask:0xf
s_waitcnt vmcnt(31)
s_nop 0
v_mfma_f32_16x16x32_bf16 v[48:51], v[24:27], v[64:67], v[48:51]
v_and_b32_dpp v28, v13, v20 row_newbcast:1 row_mask:0xf bank_mask:0xf
v_and_b32_dpp v29, v13, v21 row_newbcast:1 row_mask:0xf bank_mask:0xf
v_and_b32_dpp v30, v13, v22 row_newbcast:1 row_mask:0xf bank_mask:0xf
v_and_b32_dpp v31, v13, v23 row_newbcast:1 row_mask:0xf bank_mask:0xf
s_waitcnt vmcnt(30)
s_nop 0
v_mfma_f32_16x16x32_bf16 v[48:51], v[28:31], v[68:71], v[48:51]
v_and_b32_dpp v24, v13, v20 row_newbcast:2 row_mask:0xf bank_mask:0xf
v_and_b32_dpp v25, v13, v21 row_newbcast:2 row_mask:0xf bank_mask:0xf
v_and_b32_dpp v26, v13, v22 row_newbcast:2 row_mask:0xf bank_mask:0xf
v_and_b32_dpp v27, v13, v23 row_newbcast:2 row_mask:0xf bank_mask:0xf
s_waitcnt vmcnt(29)
s_nop 0
v_mfma_f32_16x16x32_bf16 v[48:51], v[24:27], v[72:75], v[48:51]
v_and_b32_dpp v28, v13, v20 row_newbcast:3 row_mask:0xf bank_mask:0xf
v_and_b32_dpp v29, v13, v21 row_newbcast:3 row_mask:0xf bank_mask:0xf
v_and_b32_dpp v30, v13, v22 row_newbcast:3 row_mask:0xf bank_mask:0xf
v_and_b32_dpp v31, v13, v23 row_newbcast:3 row_mask:0xf bank_mask:0xf
s_waitcnt vmcnt(28)
s_nop 0
v_mfma_f32_16x16x32_bf16 v[48:51], v[28:31], v[76:79], v[48:51]
v_and_b32_dpp v24, v13, v20 row_newbcast:4 row_mask:0xf bank_mask:0xf
v_and_b32_dpp v25, v13, v21 row_newbcast:4 row_mask:0xf bank_mask:0xf
v_and_b32_dpp v26, v13, v22 row_newbcast:4 row_mask:0xf bank_mask:0xf
v_and_b32_dpp v27, v13, v23 row_newbcast:4 row_mask:0xf bank_mask:0xf
s_waitcnt vmcnt(27)
s_nop 0
v_mfma_f32_16x16x32_bf16 v[48:51], v[24:27], v[80:83], v[48:51]
v_and_b32_dpp v28, v13, v20 row_newbcast:5 row_mask:0xf bank_mask:0xf
v_and_b32_dpp v29, v13, v21 row_newbcast:5 row_mask:0xf bank_mask:0xf
v_and_b32_dpp v30, v13, v22 row_newbcast:5 row_mask:0xf bank_mask:0xf
v_and_b32_dpp v31, v13, v23 row_newbcast:5 row_mask:0xf bank_mask:0xf
s_waitcnt vmcnt(26)
s_nop 0
v_mfma_f32_16x16x32_bf16 v[48:51], v[28:31], v[84:87], v[48:51]
v_and_b32_dpp v24, v13, v20 row_newbcast:6 row_mask:0xf bank_mask:0xf
v_and_b32_dpp v25, v13, v21 row_newbcast:6 row_mask:0xf bank_mask:0xf
v_and_b32_dpp v26, v13, v22 row_newbcast:6 row_mask:0xf bank_mask:0xf
v_and_b32_dpp v27, v13, v23 row_newbcast:6 row_mask:0xf bank_mask:0xf
s_waitcnt vmcnt(25)
s_nop 0
v_mfma_f32_16x16x32_bf16 v[48:51], v[24:27], v[88:91], v[48:51]
ds_read_b32 v10, v8
v_add_u32 v8, s14, v8
v_and_b32_dpp v28, v13, v20 row_newbcast:7 row_mask:0xf bank_mask:0xf
v_and_b32_dpp v29, v13, v21 row_newbcast:7 row_mask:0xf bank_mask:0xf
v_and_b32_dpp v30, v13, v22 row_newbcast:7 row_mask:0xf bank_mask:0xf
v_and_b32_dpp v31, v13, v23 row_newbcast:7 row_mask:0xf bank_mask:0xf
s_waitcnt vmcnt(24)
s_nop 0
v_mfma_f32_16x16x32_bf16 v[48:51], v[28:31], v[92:95], v[48:51]
v_and_b32_dpp v24, v13, v20 row_newbcast:8 row_mask:0xf bank_mask:0xf
v_and_b32_dpp v25, v13, v21 row_newbcast:8 row_mask:0xf bank_mask:0xf
v_and_b32_dpp v26, v13, v22 row_newbcast:8 row_mask:0xf bank_mask:0xf
v_and_b32_dpp v27, v13, v23 row_newbcast:8 row_mask:0xf bank_mask:0xf
s_waitcnt vmcnt(23)
s_nop 0
v_mfma_f32_16x16x32_bf16 v[48:51], v[24:27], v[96:99], v[48:51]
v_and_b32_dpp v28, v13, v20 row_newbcast:9 row_mask:0xf bank_mask:0xf
v_and_b32_dpp v29, v13, v21 row_newbcast:9 row_mask:0xf bank_mask:0xf
v_and_b32_dpp v30, v13, v22 row_newbcast:9 row_mask:0xf bank_mask:0xf
v_and_b32_dpp v31, v13, v23 row_newbcast:9 row_mask:0xf bank_mask:0xf
s_waitcnt vmcnt(22)
s_nop 0
v_mfma_f32_16x16x32_bf16 v[48:51], v[28:31], v[100:103], v[48:51]
v_and_b32_dpp v24, v13, v20 row_newbcast:10 row_mask:0xf bank_mask:0xf
v_and_b32_dpp v25, v13, v21 row_newbcast:10 row_mask:0xf bank_mask:0xf
v_and_b32_dpp v26, v13, v22 row_newbcast:10 row_mask:0xf bank_mask:0xf
v_and_b32_dpp v27, v13, v23 row_newbcast:10 row_mask:0xf bank_mask:0xf
s_waitcnt vmcnt(21)
s_nop 0
v_mfma_f32_16x16x32_bf16 v[48:51], v[24:27], v[104:107], v[48:51]
v_and_b32_dpp v28, v13, v20 row_newbcast:11 row_mask:0xf bank_mask:0xf
v_and_b32_dpp v29, v13, v21 row_newbcast:11 row_mask:0xf bank_mask:0xf
v_and_b32_dpp v30, v13, v22 row_newbcast:11 row_mask:0xf bank_mask:0xf
v_and_b32_dpp v31, v13, v23 row_newbcast:11 row_mask:0xf bank_mask:0xf
s_waitcnt vmcnt(20)
s_nop 0
v_mfma_f32_16x16x32_bf16 v[48:51], v[28:31], v[108:111], v[48:51]
v_and_b32_dpp v24, v13, v20 row_newbcast:12 row_mask:0xf bank_mask:0xf
v_and_b32_dpp v25, v13, v21 row_newbcast:12 row_mask:0xf bank_mask:0xf
v_and_b32_dpp v26, v13, v22 row_newbcast:12 row_mask:0xf bank_mask:0xf
v_and_b32_dpp v27, v13, v23 row_newbcast:12 row_mask:0xf bank_mask:0xf
s_waitcnt vmcnt(19)
s_nop 0
v_mfma_f32_16x16x32_bf16 v[48:51], v[24:27], v[112:115], v[48:51]
v_and_b32_dpp v28, v13, v20 row_newbcast:13 row_mask:0xf bank_mask:0xf
v_and_b32_dpp v29, v13, v21 row_newbcast:13 row_mask:0xf bank_mask:0xf
v_and_b32_dpp v30, v13, v22 row_newbcast:13 row_mask:0xf bank_mask:0xf
v_and_b32_dpp v31, v13, v23 row_newbcast:13 row_mask:0xf bank_mask:0xf
s_waitcnt vmcnt(18)
s_nop 0
v_mfma_f32_16x16x32_bf16 v[48:51], v[28:31], v[116:119], v[48:51]
v_and_b32_dpp v24, v13, v20 row_newbcast:14 row_mask:0xf bank_mask:0xf
v_and_b32_dpp v25, v13, v21 row_newbcast:14 row_mask:0xf bank_mask:0xf
v_and_b32_dpp v26, v13, v22 row_newbcast:14 row_mask:0xf bank_mask:0xf
v_and_b32_dpp v27, v13, v23 row_newbcast:14 row_mask:0xf bank_mask:0xf
s_waitcnt vmcnt(17)
s_nop 0
v_mfma_f32_16x16x32_bf16 v[48:51], v[24:27], v[120:123], v[48:51]
v_and_b32_dpp v28, v13, v20 row_newbcast:15 row_mask:0xf bank_mask:0xf
v_and_b32_dpp v29, v13, v21 row_newbcast:15 row_mask:0xf bank_mask:0xf
v_and_b32_dpp v30, v13, v22 row_newbcast:15 row_mask:0xf bank_mask:0xf
v_and_b32_dpp v31, v13, v23 row_newbcast:15 row_mask:0xf bank_mask:0xf
s_waitcnt vmcnt(16)
s_nop 0
v_mfma_f32_16x16x32_bf16 v[48:51], v[28:31], v[124:127], v[48:51]
s_waitcnt lgkmcnt(0)
v_lshlrev_b32 v16, v53, v10
v_and_b32 v16, 0xffff0000, v16
s_nop 1
v_max_f32_dpp v14, v16, v16 row_ror:8 row_mask:0xf bank_mask:0xf
s_nop 1
v_max_f32_dpp v14, v14, v14 row_ror:4 row_mask:0xf bank_mask:0xf
s_nop 1
v_max_f32_dpp v14, v14, v14 row_ror:2 row_mask:0xf bank_mask:0xf
s_nop 1
v_max_f32_dpp v14, v14, v14 row_ror:1 row_mask:0xf bank_mask:0xf
v_mov_b32 v15, v14
s_nop 1
v_permlane32_swap_b32 v14, v15
v_max_f32 v14, v14, v15
v_max_f32 v14, v14, v52
v_sub_f32 v15, v52, v14
v_sub_f32 v16, v16, v14
v_mov_b32 v52, v14
v_mul_f32 v15, s88, v15
v_mul_f32 v16, s88, v16
v_exp_f32 v15, v15
v_exp_f32 v16, v16
s_nop 0
v_cvt_pk_bf16_f32 v13, v16, v16
v_fma_f32 v12, v12, v15, v16
v_mul_f32 v48, v48, v15
v_mul_f32 v49, v49, v15
v_mul_f32 v50, v50, v15
v_mul_f32 v51, v51, v15
v_add_f32_dpp v12, v12, v12 row_ror:8 row_mask:0xf bank_mask:0xf
s_nop 1
v_add_f32_dpp v12, v12, v12 row_ror:4 row_mask:0xf bank_mask:0xf
s_nop 1
v_add_f32_dpp v12, v12, v12 row_ror:2 row_mask:0xf bank_mask:0xf
s_nop 1
v_add_f32_dpp v12, v12, v12 row_ror:1 row_mask:0xf bank_mask:0xf
v_mov_b32 v14, v12
s_nop 1
v_permlane32_swap_b32 v12, v14
v_add_f32 v12, v12, v14
s_lshl_b32 s8, s3, 2
v_mov_b32 v16, s8
ds_write_b32 v16, v52 offset:512
ds_write_b32 v16, v12 offset:528
v_lshlrev_b32 v15, 4, v0
v_mov_b32 v16, 0
v_and_b32_dpp v24, v13, v20 row_newbcast:0 row_mask:0xf bank_mask:0xf
v_and_b32_dpp v25, v13, v21 row_newbcast:0 row_mask:0xf bank_mask:0xf
v_and_b32_dpp v26, v13, v22 row_newbcast:0 row_mask:0xf bank_mask:0xf
v_and_b32_dpp v27, v13, v23 row_newbcast:0 row_mask:0xf bank_mask:0xf
s_waitcnt vmcnt(15)
s_nop 0
v_mfma_f32_16x16x32_bf16 v[48:51], v[24:27], v[128:131], v[48:51]
v_and_b32_dpp v28, v13, v20 row_newbcast:1 row_mask:0xf bank_mask:0xf
v_and_b32_dpp v29, v13, v21 row_newbcast:1 row_mask:0xf bank_mask:0xf
v_and_b32_dpp v30, v13, v22 row_newbcast:1 row_mask:0xf bank_mask:0xf
v_and_b32_dpp v31, v13, v23 row_newbcast:1 row_mask:0xf bank_mask:0xf
s_waitcnt vmcnt(14)
s_nop 0
v_mfma_f32_16x16x32_bf16 v[48:51], v[28:31], v[132:135], v[48:51]
v_and_b32_dpp v24, v13, v20 row_newbcast:2 row_mask:0xf bank_mask:0xf
v_and_b32_dpp v25, v13, v21 row_newbcast:2 row_mask:0xf bank_mask:0xf
v_and_b32_dpp v26, v13, v22 row_newbcast:2 row_mask:0xf bank_mask:0xf
v_and_b32_dpp v27, v13, v23 row_newbcast:2 row_mask:0xf bank_mask:0xf
s_waitcnt vmcnt(13)
s_nop 0
v_mfma_f32_16x16x32_bf16 v[48:51], v[24:27], v[136:139], v[48:51]
v_and_b32_dpp v28, v13, v20 row_newbcast:3 row_mask:0xf bank_mask:0xf
v_and_b32_dpp v29, v13, v21 row_newbcast:3 row_mask:0xf bank_mask:0xf
v_and_b32_dpp v30, v13, v22 row_newbcast:3 row_mask:0xf bank_mask:0xf
v_and_b32_dpp v31, v13, v23 row_newbcast:3 row_mask:0xf bank_mask:0xf
s_waitcnt vmcnt(12)
s_nop 0
v_mfma_f32_16x16x32_bf16 v[48:51], v[28:31], v[140:143], v[48:51]
v_and_b32_dpp v24, v13, v20 row_newbcast:4 row_mask:0xf bank_mask:0xf
v_and_b32_dpp v25, v13, v21 row_newbcast:4 row_mask:0xf bank_mask:0xf
v_and_b32_dpp v26, v13, v22 row_newbcast:4 row_mask:0xf bank_mask:0xf
v_and_b32_dpp v27, v13, v23 row_newbcast:4 row_mask:0xf bank_mask:0xf
s_waitcnt vmcnt(11)
s_nop 0
v_mfma_f32_16x16x32_bf16 v[48:51], v[24:27], v[144:147], v[48:51]
v_and_b32_dpp v28, v13, v20 row_newbcast:5 row_mask:0xf bank_mask:0xf
v_and_b32_dpp v29, v13, v21 row_newbcast:5 row_mask:0xf bank_mask:0xf
v_and_b32_dpp v30, v13, v22 row_newbcast:5 row_mask:0xf bank_mask:0xf
v_and_b32_dpp v31, v13, v23 row_newbcast:5 row_mask:0xf bank_mask:0xf
s_waitcnt vmcnt(10)
s_nop 0
v_mfma_f32_16x16x32_bf16 v[48:51], v[28:31], v[148:151], v[48:51]
v_and_b32_dpp v24, v13, v20 row_newbcast:6 row_mask:0xf bank_mask:0xf
v_and_b32_dpp v25, v13, v21 row_newbcast:6 row_mask:0xf bank_mask:0xf
v_and_b32_dpp v26, v13, v22 row_newbcast:6 row_mask:0xf bank_mask:0xf
v_and_b32_dpp v27, v13, v23 row_newbcast:6 row_mask:0xf bank_mask:0xf
s_waitcnt vmcnt(9)
s_nop 0
v_mfma_f32_16x16x32_bf16 v[48:51], v[24:27], v[152:155], v[48:51]
v_and_b32_dpp v28, v13, v20 row_newbcast:7 row_mask:0xf bank_mask:0xf
v_and_b32_dpp v29, v13, v21 row_newbcast:7 row_mask:0xf bank_mask:0xf
v_and_b32_dpp v30, v13, v22 row_newbcast:7 row_mask:0xf bank_mask:0xf
v_and_b32_dpp v31, v13, v23 row_newbcast:7 row_mask:0xf bank_mask:0xf
s_waitcnt vmcnt(8)
s_nop 0
v_mfma_f32_16x16x32_bf16 v[48:51], v[28:31], v[156:159], v[48:51]
v_and_b32_dpp v24, v13, v20 row_newbcast:8 row_mask:0xf bank_mask:0xf
v_and_b32_dpp v25, v13, v21 row_newbcast:8 row_mask:0xf bank_mask:0xf
v_and_b32_dpp v26, v13, v22 row_newbcast:8 row_mask:0xf bank_mask:0xf
v_and_b32_dpp v27, v13, v23 row_newbcast:8 row_mask:0xf bank_mask:0xf
s_waitcnt vmcnt(7)
s_nop 0
v_mfma_f32_16x16x32_bf16 v[48:51], v[24:27], v[160:163], v[48:51]
v_and_b32_dpp v28, v13, v20 row_newbcast:9 row_mask:0xf bank_mask:0xf
v_and_b32_dpp v29, v13, v21 row_newbcast:9 row_mask:0xf bank_mask:0xf
v_and_b32_dpp v30, v13, v22 row_newbcast:9 row_mask:0xf bank_mask:0xf
v_and_b32_dpp v31, v13, v23 row_newbcast:9 row_mask:0xf bank_mask:0xf
s_waitcnt vmcnt(6)
s_nop 0
v_mfma_f32_16x16x32_bf16 v[48:51], v[28:31], v[164:167], v[48:51]
v_and_b32_dpp v24, v13, v20 row_newbcast:10 row_mask:0xf bank_mask:0xf
v_and_b32_dpp v25, v13, v21 row_newbcast:10 row_mask:0xf bank_mask:0xf
v_and_b32_dpp v26, v13, v22 row_newbcast:10 row_mask:0xf bank_mask:0xf
v_and_b32_dpp v27, v13, v23 row_newbcast:10 row_mask:0xf bank_mask:0xf
s_waitcnt vmcnt(5)
s_nop 0
v_mfma_f32_16x16x32_bf16 v[48:51], v[24:27], v[168:171], v[48:51]
v_and_b32_dpp v28, v13, v20 row_newbcast:11 row_mask:0xf bank_mask:0xf
v_and_b32_dpp v29, v13, v21 row_newbcast:11 row_mask:0xf bank_mask:0xf
v_and_b32_dpp v30, v13, v22 row_newbcast:11 row_mask:0xf bank_mask:0xf
v_and_b32_dpp v31, v13, v23 row_newbcast:11 row_mask:0xf bank_mask:0xf
s_waitcnt vmcnt(4)
s_nop 0
v_mfma_f32_16x16x32_bf16 v[48:51], v[28:31], v[172:175], v[48:51]
v_and_b32_dpp v24, v13, v20 row_newbcast:12 row_mask:0xf bank_mask:0xf
v_and_b32_dpp v25, v13, v21 row_newbcast:12 row_mask:0xf bank_mask:0xf
v_and_b32_dpp v26, v13, v22 row_newbcast:12 row_mask:0xf bank_mask:0xf
v_and_b32_dpp v27, v13, v23 row_newbcast:12 row_mask:0xf bank_mask:0xf
s_waitcnt vmcnt(3)
s_nop 0
v_mfma_f32_16x16x32_bf16 v[48:51], v[24:27], v[176:179], v[48:51]
v_and_b32_dpp v28, v13, v20 row_newbcast:13 row_mask:0xf bank_mask:0xf
v_and_b32_dpp v29, v13, v21 row_newbcast:13 row_mask:0xf bank_mask:0xf
v_and_b32_dpp v30, v13, v22 row_newbcast:13 row_mask:0xf bank_mask:0xf
v_and_b32_dpp v31, v13, v23 row_newbcast:13 row_mask:0xf bank_mask:0xf
s_waitcnt vmcnt(2)
s_nop 0
v_mfma_f32_16x16x32_bf16 v[48:51], v[28:31], v[180:183], v[48:51]
v_and_b32_dpp v24, v13, v20 row_newbcast:14 row_mask:0xf bank_mask:0xf
v_and_b32_dpp v25, v13, v21 row_newbcast:14 row_mask:0xf bank_mask:0xf
v_and_b32_dpp v26, v13, v22 row_newbcast:14 row_mask:0xf bank_mask:0xf
v_and_b32_dpp v27, v13, v23 row_newbcast:14 row_mask:0xf bank_mask:0xf
s_waitcnt vmcnt(1)
s_nop 0
v_mfma_f32_16x16x32_bf16 v[48:51], v[24:27], v[184:187], v[48:51]
v_and_b32_dpp v28, v13, v20 row_newbcast:15 row_mask:0xf bank_mask:0xf
v_and_b32_dpp v29, v13, v21 row_newbcast:15 row_mask:0xf bank_mask:0xf
v_and_b32_dpp v30, v13, v22 row_newbcast:15 row_mask:0xf bank_mask:0xf
v_and_b32_dpp v31, v13, v23 row_newbcast:15 row_mask:0xf bank_mask:0xf
s_waitcnt vmcnt(0)
s_nop 0
v_mfma_f32_16x16x32_bf16 v[48:51], v[28:31], v[188:191], v[48:51]
s_branch v_end
v_last0:
s_mov_b32 s52, s24
s_mov_b32 s53, s25
s_mov_b32 s54, 0x380000
s_mov_b32 s55, 0x20000
v_lshrrev_b32 v46, 4, v1
v_mul_u32_u24 v19, 1792, v46
v_and_b32 v18, 15, v1
v_lshlrev_b32 v18, 4, v18
v_lshl_add_u32 v46, v19, 1, v18
v_add_u32 v19, v19, v18
v_and_b32 v18, 7, v1
v_lshlrev_b32 v18, 6, v18
v_and_b32 v47, 56, v1
v_add_u32 v18, v18, v47
s_mul_i32 s10, s2, 14336
s_min_u32 s9, s2, 223
s_mul_i32 s9, s9, 7168
s_lshl_b32 s12, s2, 10
s_add_u32 s12, s12, 3145728
v_and_b32_dpp v24, v13, v20 row_newbcast:0 row_mask:0xf bank_mask:0xf
v_and_b32_dpp v25, v13, v21 row_newbcast:0 row_mask:0xf bank_mask:0xf
v_and_b32_dpp v26, v13, v22 row_newbcast:0 row_mask:0xf bank_mask:0xf
v_and_b32_dpp v27, v13, v23 row_newbcast:0 row_mask:0xf bank_mask:0xf
s_waitcnt vmcnt(31)
s_nop 0
v_mfma_f32_16x16x32_bf16 v[48:51], v[24:27], v[64:67], v[48:51]
v_and_b32_dpp v28, v13, v20 row_newbcast:1 row_mask:0xf bank_mask:0xf
v_and_b32_dpp v29, v13, v21 row_newbcast:1 row_mask:0xf bank_mask:0xf
v_and_b32_dpp v30, v13, v22 row_newbcast:1 row_mask:0xf bank_mask:0xf
v_and_b32_dpp v31, v13, v23 row_newbcast:1 row_mask:0xf bank_mask:0xf
s_waitcnt vmcnt(30)
s_nop 0
v_mfma_f32_16x16x32_bf16 v[48:51], v[28:31], v[68:71], v[48:51]
v_and_b32_dpp v24, v13, v20 row_newbcast:2 row_mask:0xf bank_mask:0xf
v_and_b32_dpp v25, v13, v21 row_newbcast:2 row_mask:0xf bank_mask:0xf
v_and_b32_dpp v26, v13, v22 row_newbcast:2 row_mask:0xf bank_mask:0xf
v_and_b32_dpp v27, v13, v23 row_newbcast:2 row_mask:0xf bank_mask:0xf
s_waitcnt vmcnt(29)
s_nop 0
v_mfma_f32_16x16x32_bf16 v[48:51], v[24:27], v[72:75], v[48:51]
v_and_b32_dpp v28, v13, v20 row_newbcast:3 row_mask:0xf bank_mask:0xf
v_and_b32_dpp v29, v13, v21 row_newbcast:3 row_mask:0xf bank_mask:0xf
v_and_b32_dpp v30, v13, v22 row_newbcast:3 row_mask:0xf bank_mask:0xf
v_and_b32_dpp v31, v13, v23 row_newbcast:3 row_mask:0xf bank_mask:0xf
s_waitcnt vmcnt(28)
s_nop 0
v_mfma_f32_16x16x32_bf16 v[48:51], v[28:31], v[76:79], v[48:51]
v_and_b32_dpp v24, v13, v20 row_newbcast:4 row_mask:0xf bank_mask:0xf
v_and_b32_dpp v25, v13, v21 row_newbcast:4 row_mask:0xf bank_mask:0xf
v_and_b32_dpp v26, v13, v22 row_newbcast:4 row_mask:0xf bank_mask:0xf
v_and_b32_dpp v27, v13, v23 row_newbcast:4 row_mask:0xf bank_mask:0xf
s_waitcnt vmcnt(27)
s_nop 0
v_mfma_f32_16x16x32_bf16 v[48:51], v[24:27], v[80:83], v[48:51]
v_and_b32_dpp v28, v13, v20 row_newbcast:5 row_mask:0xf bank_mask:0xf
v_and_b32_dpp v29, v13, v21 row_newbcast:5 row_mask:0xf bank_mask:0xf
v_and_b32_dpp v30, v13, v22 row_newbcast:5 row_mask:0xf bank_mask:0xf
v_and_b32_dpp v31, v13, v23 row_newbcast:5 row_mask:0xf bank_mask:0xf
s_waitcnt vmcnt(26)
s_nop 0
v_mfma_f32_16x16x32_bf16 v[48:51], v[28:31], v[84:87], v[48:51]
v_and_b32_dpp v24, v13, v20 row_newbcast:6 row_mask:0xf bank_mask:0xf
v_and_b32_dpp v25, v13, v21 row_newbcast:6 row_mask:0xf bank_mask:0xf
v_and_b32_dpp v26, v13, v22 row_newbcast:6 row_mask:0xf bank_mask:0xf
v_and_b32_dpp v27, v13, v23 row_newbcast:6 row_mask:0xf bank_mask:0xf
s_waitcnt vmcnt(25)
s_nop 0
v_mfma_f32_16x16x32_bf16 v[48:51], v[24:27], v[88:91], v[48:51]
ds_read_b32 v10, v8
v_add_u32 v8, s14, v8
v_and_b32_dpp v28, v13, v20 row_newbcast:7 row_mask:0xf bank_mask:0xf
v_and_b32_dpp v29, v13, v21 row_newbcast:7 row_mask:0xf bank_mask:0xf
v_and_b32_dpp v30, v13, v22 row_newbcast:7 row_mask:0xf bank_mask:0xf
v_and_b32_dpp v31, v13, v23 row_newbcast:7 row_mask:0xf bank_mask:0xf
s_waitcnt vmcnt(24)
s_nop 0
v_mfma_f32_16x16x32_bf16 v[48:51], v[28:31], v[92:95], v[48:51]
v_and_b32_dpp v24, v13, v20 row_newbcast:8 row_mask:0xf bank_mask:0xf
v_and_b32_dpp v25, v13, v21 row_newbcast:8 row_mask:0xf bank_mask:0xf
v_and_b32_dpp v26, v13, v22 row_newbcast:8 row_mask:0xf bank_mask:0xf
v_and_b32_dpp v27, v13, v23 row_newbcast:8 row_mask:0xf bank_mask:0xf
s_waitcnt vmcnt(23)
s_nop 0
v_mfma_f32_16x16x32_bf16 v[48:51], v[24:27], v[96:99], v[48:51]
v_and_b32_dpp v28, v13, v20 row_newbcast:9 row_mask:0xf bank_mask:0xf
v_and_b32_dpp v29, v13, v21 row_newbcast:9 row_mask:0xf bank_mask:0xf
v_and_b32_dpp v30, v13, v22 row_newbcast:9 row_mask:0xf bank_mask:0xf
v_and_b32_dpp v31, v13, v23 row_newbcast:9 row_mask:0xf bank_mask:0xf
s_waitcnt vmcnt(22)
s_nop 0
v_mfma_f32_16x16x32_bf16 v[48:51], v[28:31], v[100:103], v[48:51]
v_and_b32_dpp v24, v13, v20 row_newbcast:10 row_mask:0xf bank_mask:0xf
v_and_b32_dpp v25, v13, v21 row_newbcast:10 row_mask:0xf bank_mask:0xf
v_and_b32_dpp v26, v13, v22 row_newbcast:10 row_mask:0xf bank_mask:0xf
v_and_b32_dpp v27, v13, v23 row_newbcast:10 row_mask:0xf bank_mask:0xf
s_waitcnt vmcnt(21)
s_nop 0
v_mfma_f32_16x16x32_bf16 v[48:51], v[24:27], v[104:107], v[48:51]
v_and_b32_dpp v28, v13, v20 row_newbcast:11 row_mask:0xf bank_mask:0xf
v_and_b32_dpp v29, v13, v21 row_newbcast:11 row_mask:0xf bank_mask:0xf
v_and_b32_dpp v30, v13, v22 row_newbcast:11 row_mask:0xf bank_mask:0xf
v_and_b32_dpp v31, v13, v23 row_newbcast:11 row_mask:0xf bank_mask:0xf
s_waitcnt vmcnt(20)
s_nop 0
v_mfma_f32_16x16x32_bf16 v[48:51], v[28:31], v[108:111], v[48:51]
v_and_b32_dpp v24, v13, v20 row_newbcast:12 row_mask:0xf bank_mask:0xf
v_and_b32_dpp v25, v13, v21 row_newbcast:12 row_mask:0xf bank_mask:0xf
v_and_b32_dpp v26, v13, v22 row_newbcast:12 row_mask:0xf bank_mask:0xf
v_and_b32_dpp v27, v13, v23 row_newbcast:12 row_mask:0xf bank_mask:0xf
s_waitcnt vmcnt(19)
s_nop 0
v_mfma_f32_16x16x32_bf16 v[48:51], v[24:27], v[112:115], v[48:51]
v_and_b32_dpp v28, v13, v20 row_newbcast:13 row_mask:0xf bank_mask:0xf
v_and_b32_dpp v29, v13, v21 row_newbcast:13 row_mask:0xf bank_mask:0xf
v_and_b32_dpp v30, v13, v22 row_newbcast:13 row_mask:0xf bank_mask:0xf
v_and_b32_dpp v31, v13, v23 row_newbcast:13 row_mask:0xf bank_mask:0xf
s_waitcnt vmcnt(18)
s_nop 0
v_mfma_f32_16x16x32_bf16 v[48:51], v[28:31], v[116:119], v[48:51]
v_and_b32_dpp v24, v13, v20 row_newbcast:14 row_mask:0xf bank_mask:0xf
v_and_b32_dpp v25, v13, v21 row_newbcast:14 row_mask:0xf bank_mask:0xf
v_and_b32_dpp v26, v13, v22 row_newbcast:14 row_mask:0xf bank_mask:0xf
v_and_b32_dpp v27, v13, v23 row_newbcast:14 row_mask:0xf bank_mask:0xf
s_waitcnt vmcnt(17)
s_nop 0
v_mfma_f32_16x16x32_bf16 v[48:51], v[24:27], v[120:123], v[48:51]
v_and_b32_dpp v28, v13, v20 row_newbcast:15 row_mask:0xf bank_mask:0xf
v_and_b32_dpp v29, v13, v21 row_newbcast:15 row_mask:0xf bank_mask:0xf
v_and_b32_dpp v30, v13, v22 row_newbcast:15 row_mask:0xf bank_mask:0xf
v_and_b32_dpp v31, v13, v23 row_newbcast:15 row_mask:0xf bank_mask:0xf
s_waitcnt vmcnt(16)
s_nop 0
v_mfma_f32_16x16x32_bf16 v[48:51], v[28:31], v[124:127], v[48:51]
buffer_load_dwordx2 v[42:43], v18, s[48:51], s12 offen sc1
s_waitcnt lgkmcnt(0)
v_lshlrev_b32 v16, v53, v10
buffer_load_dwordx2 v[32:33], v18, s[48:51], s12 offen offset:512 sc1
v_and_b32 v16, 0xffff0000, v16
s_nop 1
v_max_f32_dpp v14, v16, v16 row_ror:8 row_mask:0xf bank_mask:0xf
buffer_load_dwordx4 v[192:195], v19, s[68:71], s9 offen offset:0 nt
s_nop 0
v_max_f32_dpp v14, v14, v14 row_ror:4 row_mask:0xf bank_mask:0xf
s_nop 1
v_max_f32_dpp v14, v14, v14 row_ror:2 row_mask:0xf bank_mask:0xf
buffer_load_dwordx4 v[196:199], v19, s[68:71], s9 offen offset:256 nt
s_nop 0
v_max_f32_dpp v14, v14, v14 row_ror:1 row_mask:0xf bank_mask:0xf
v_mov_b32 v15, v14
buffer_load_dwordx4 v[200:203], v19, s[68:71], s9 offen offset:512 nt
s_nop 0
v_permlane32_swap_b32 v14, v15
v_max_f32 v14, v14, v15
buffer_load_dwordx4 v[204:207], v19, s[68:71], s9 offen offset:768 nt
v_max_f32 v14, v14, v52
v_sub_f32 v15, v52, v14
buffer_load_dwordx4 v[208:211], v19, s[68:71], s9 offen offset:896 nt
v_sub_f32 v16, v16, v14
v_mov_b32 v52, v14
buffer_load_dwordx4 v[212:215], v19, s[68:71], s9 offen offset:1152 nt
v_mul_f32 v15, s88, v15
v_mul_f32 v16, s88, v16
buffer_load_dwordx4 v[216:219], v19, s[68:71], s9 offen offset:1408 nt
v_exp_f32 v15, v15
v_exp_f32 v16, v16
buffer_load_dwordx4 v[220:223], v19, s[68:71], s9 offen offset:1664 nt
v_cvt_pk_bf16_f32 v13, v16, v16
v_fma_f32 v12, v12, v15, v16
buffer_load_dwordx4 v[64:67], v46, s[52:55], s10 offen offset:0 nt
v_mul_f32 v48, v48, v15
v_mul_f32 v49, v49, v15
buffer_load_dwordx4 v[68:71], v46, s[52:55], s10 offen offset:256 nt
v_mul_f32 v50, v50, v15
v_mul_f32 v51, v51, v15
buffer_load_dwordx4 v[72:75], v46, s[52:55], s10 offen offset:512 nt
v_add_f32_dpp v12, v12, v12 row_ror:8 row_mask:0xf bank_mask:0xf
s_nop 1
v_add_f32_dpp v12, v12, v12 row_ror:4 row_mask:0xf bank_mask:0xf
buffer_load_dwordx4 v[76:79], v46, s[52:55], s10 offen offset:768 nt
s_nop 0
v_add_f32_dpp v12, v12, v12 row_ror:2 row_mask:0xf bank_mask:0xf
s_nop 1
v_add_f32_dpp v12, v12, v12 row_ror:1 row_mask:0xf bank_mask:0xf
buffer_load_dwordx4 v[80:83], v46, s[52:55], s10 offen offset:896 nt
v_mov_b32 v14, v12
s_nop 1
v_permlane32_swap_b32 v12, v14
buffer_load_dwordx4 v[84:87], v46, s[52:55], s10 offen offset:1152 nt
v_add_f32 v12, v12, v14
s_lshl_b32 s8, s3, 2
buffer_load_dwordx4 v[88:91], v46, s[52:55], s10 offen offset:1408 nt
v_mov_b32 v16, s8
ds_write_b32 v16, v52 offset:512
buffer_load_dwordx4 v[92:95], v46, s[52:55], s10 offen offset:1664 nt
ds_write_b32 v16, v12 offset:528
v_lshlrev_b32 v15, 4, v0
buffer_load_dwordx4 v[96:99], v46, s[52:55], s10 offen offset:1792 nt
v_mov_b32 v16, 0
buffer_load_dwordx4 v[100:103], v46, s[52:55], s10 offen offset:2048 nt
buffer_load_dwordx4 v[104:107], v46, s[52:55], s10 offen offset:2304 nt
buffer_load_dwordx4 v[108:111], v46, s[52:55], s10 offen offset:2560 nt
buffer_load_dwordx4 v[112:115], v46, s[52:55], s10 offen offset:2688 nt
buffer_load_dwordx4 v[116:119], v46, s[52:55], s10 offen offset:2944 nt
buffer_load_dwordx4 v[120:123], v46, s[52:55], s10 offen offset:3200 nt
buffer_load_dwordx4 v[124:127], v46, s[52:55], s10 offen offset:3456 nt
v_and_b32_dpp v24, v13, v20 row_newbcast:0 row_mask:0xf bank_mask:0xf
v_and_b32_dpp v25, v13, v21 row_newbcast:0 row_mask:0xf bank_mask:0xf
v_and_b32_dpp v26, v13, v22 row_newbcast:0 row_mask:0xf bank_mask:0xf
v_and_b32_dpp v27, v13, v23 row_newbcast:0 row_mask:0xf bank_mask:0xf
s_waitcnt vmcnt(41)
s_nop 0
v_mfma_f32_16x16x32_bf16 v[48:51], v[24:27], v[128:131], v[48:51]
v_and_b32_dpp v28, v13, v20 row_newbcast:1 row_mask:0xf bank_mask:0xf
v_and_b32_dpp v29, v13, v21 row_newbcast:1 row_mask:0xf bank_mask:0xf
v_and_b32_dpp v30, v13, v22 row_newbcast:1 row_mask:0xf bank_mask:0xf
v_and_b32_dpp v31, v13, v23 row_newbcast:1 row_mask:0xf bank_mask:0xf
s_waitcnt vmcnt(40)
s_nop 0
v_mfma_f32_16x16x32_bf16 v[48:51], v[28:31], v[132:135], v[48:51]
v_and_b32_dpp v24, v13, v20 row_newbcast:2 row_mask:0xf bank_mask:0xf
v_and_b32_dpp v25, v13, v21 row_newbcast:2 row_mask:0xf bank_mask:0xf
v_and_b32_dpp v26, v13, v22 row_newbcast:2 row_mask:0xf bank_mask:0xf
v_and_b32_dpp v27, v13, v23 row_newbcast:2 row_mask:0xf bank_mask:0xf
s_waitcnt vmcnt(39)
s_nop 0
v_mfma_f32_16x16x32_bf16 v[48:51], v[24:27], v[136:139], v[48:51]
v_and_b32_dpp v28, v13, v20 row_newbcast:3 row_mask:0xf bank_mask:0xf
v_and_b32_dpp v29, v13, v21 row_newbcast:3 row_mask:0xf bank_mask:0xf
v_and_b32_dpp v30, v13, v22 row_newbcast:3 row_mask:0xf bank_mask:0xf
v_and_b32_dpp v31, v13, v23 row_newbcast:3 row_mask:0xf bank_mask:0xf
s_waitcnt vmcnt(38)
s_nop 0
v_mfma_f32_16x16x32_bf16 v[48:51], v[28:31], v[140:143], v[48:51]
v_and_b32_dpp v24, v13, v20 row_newbcast:4 row_mask:0xf bank_mask:0xf
v_and_b32_dpp v25, v13, v21 row_newbcast:4 row_mask:0xf bank_mask:0xf
v_and_b32_dpp v26, v13, v22 row_newbcast:4 row_mask:0xf bank_mask:0xf
v_and_b32_dpp v27, v13, v23 row_newbcast:4 row_mask:0xf bank_mask:0xf
s_waitcnt vmcnt(37)
s_nop 0
v_mfma_f32_16x16x32_bf16 v[48:51], v[24:27], v[144:147], v[48:51]
v_and_b32_dpp v28, v13, v20 row_newbcast:5 row_mask:0xf bank_mask:0xf
v_and_b32_dpp v29, v13, v21 row_newbcast:5 row_mask:0xf bank_mask:0xf
v_and_b32_dpp v30, v13, v22 row_newbcast:5 row_mask:0xf bank_mask:0xf
v_and_b32_dpp v31, v13, v23 row_newbcast:5 row_mask:0xf bank_mask:0xf
s_waitcnt vmcnt(36)
s_nop 0
v_mfma_f32_16x16x32_bf16 v[48:51], v[28:31], v[148:151], v[48:51]
v_and_b32_dpp v24, v13, v20 row_newbcast:6 row_mask:0xf bank_mask:0xf
v_and_b32_dpp v25, v13, v21 row_newbcast:6 row_mask:0xf bank_mask:0xf
v_and_b32_dpp v26, v13, v22 row_newbcast:6 row_mask:0xf bank_mask:0xf
v_and_b32_dpp v27, v13, v23 row_newbcast:6 row_mask:0xf bank_mask:0xf
s_waitcnt vmcnt(35)
s_nop 0
v_mfma_f32_16x16x32_bf16 v[48:51], v[24:27], v[152:155], v[48:51]
v_and_b32_dpp v28, v13, v20 row_newbcast:7 row_mask:0xf bank_mask:0xf
v_and_b32_dpp v29, v13, v21 row_newbcast:7 row_mask:0xf bank_mask:0xf
v_and_b32_dpp v30, v13, v22 row_newbcast:7 row_mask:0xf bank_mask:0xf
v_and_b32_dpp v31, v13, v23 row_newbcast:7 row_mask:0xf bank_mask:0xf
s_waitcnt vmcnt(34)
s_nop 0
v_mfma_f32_16x16x32_bf16 v[48:51], v[28:31], v[156:159], v[48:51]
v_and_b32_dpp v24, v13, v20 row_newbcast:8 row_mask:0xf bank_mask:0xf
v_and_b32_dpp v25, v13, v21 row_newbcast:8 row_mask:0xf bank_mask:0xf
v_and_b32_dpp v26, v13, v22 row_newbcast:8 row_mask:0xf bank_mask:0xf
v_and_b32_dpp v27, v13, v23 row_newbcast:8 row_mask:0xf bank_mask:0xf
s_waitcnt vmcnt(33)
s_nop 0
v_mfma_f32_16x16x32_bf16 v[48:51], v[24:27], v[160:163], v[48:51]
v_and_b32_dpp v28, v13, v20 row_newbcast:9 row_mask:0xf bank_mask:0xf
v_and_b32_dpp v29, v13, v21 row_newbcast:9 row_mask:0xf bank_mask:0xf
v_and_b32_dpp v30, v13, v22 row_newbcast:9 row_mask:0xf bank_mask:0xf
v_and_b32_dpp v31, v13, v23 row_newbcast:9 row_mask:0xf bank_mask:0xf
s_waitcnt vmcnt(32)
s_nop 0
v_mfma_f32_16x16x32_bf16 v[48:51], v[28:31], v[164:167], v[48:51]
v_and_b32_dpp v24, v13, v20 row_newbcast:10 row_mask:0xf bank_mask:0xf
v_and_b32_dpp v25, v13, v21 row_newbcast:10 row_mask:0xf bank_mask:0xf
v_and_b32_dpp v26, v13, v22 row_newbcast:10 row_mask:0xf bank_mask:0xf
v_and_b32_dpp v27, v13, v23 row_newbcast:10 row_mask:0xf bank_mask:0xf
s_waitcnt vmcnt(31)
s_nop 0
v_mfma_f32_16x16x32_bf16 v[48:51], v[24:27], v[168:171], v[48:51]
v_and_b32_dpp v28, v13, v20 row_newbcast:11 row_mask:0xf bank_mask:0xf
v_and_b32_dpp v29, v13, v21 row_newbcast:11 row_mask:0xf bank_mask:0xf
v_and_b32_dpp v30, v13, v22 row_newbcast:11 row_mask:0xf bank_mask:0xf
v_and_b32_dpp v31, v13, v23 row_newbcast:11 row_mask:0xf bank_mask:0xf
s_waitcnt vmcnt(30)
s_nop 0
v_mfma_f32_16x16x32_bf16 v[48:51], v[28:31], v[172:175], v[48:51]
v_and_b32_dpp v24, v13, v20 row_newbcast:12 row_mask:0xf bank_mask:0xf
v_and_b32_dpp v25, v13, v21 row_newbcast:12 row_mask:0xf bank_mask:0xf
v_and_b32_dpp v26, v13, v22 row_newbcast:12 row_mask:0xf bank_mask:0xf
v_and_b32_dpp v27, v13, v23 row_newbcast:12 row_mask:0xf bank_mask:0xf
s_waitcnt vmcnt(29)
s_nop 0
v_mfma_f32_16x16x32_bf16 v[48:51], v[24:27], v[176:179], v[48:51]
v_and_b32_dpp v28, v13, v20 row_newbcast:13 row_mask:0xf bank_mask:0xf
v_and_b32_dpp v29, v13, v21 row_newbcast:13 row_mask:0xf bank_mask:0xf
v_and_b32_dpp v30, v13, v22 row_newbcast:13 row_mask:0xf bank_mask:0xf
v_and_b32_dpp v31, v13, v23 row_newbcast:13 row_mask:0xf bank_mask:0xf
s_waitcnt vmcnt(28)
s_nop 0
v_mfma_f32_16x16x32_bf16 v[48:51], v[28:31], v[180:183], v[48:51]
v_and_b32_dpp v24, v13, v20 row_newbcast:14 row_mask:0xf bank_mask:0xf
v_and_b32_dpp v25, v13, v21 row_newbcast:14 row_mask:0xf bank_mask:0xf
v_and_b32_dpp v26, v13, v22 row_newbcast:14 row_mask:0xf bank_mask:0xf
v_and_b32_dpp v27, v13, v23 row_newbcast:14 row_mask:0xf bank_mask:0xf
s_waitcnt vmcnt(27)
s_nop 0
v_mfma_f32_16x16x32_bf16 v[48:51], v[24:27], v[184:187], v[48:51]
v_and_b32_dpp v28, v13, v20 row_newbcast:15 row_mask:0xf bank_mask:0xf
v_and_b32_dpp v29, v13, v21 row_newbcast:15 row_mask:0xf bank_mask:0xf
v_and_b32_dpp v30, v13, v22 row_newbcast:15 row_mask:0xf bank_mask:0xf
v_and_b32_dpp v31, v13, v23 row_newbcast:15 row_mask:0xf bank_mask:0xf
s_waitcnt vmcnt(26)
s_nop 0
v_mfma_f32_16x16x32_bf16 v[48:51], v[28:31], v[188:191], v[48:51]
v_end:
s_nop 7
ds_write_b128 v15, v[48:51] offset:1024
s_waitcnt lgkmcnt(0)
s_barrier
s_cmp_eq_u32 s3, 0
s_cbranch_scc1 tail0
s_cmp_ge_u32 s2, 112
s_cbranch_scc1 main_fin
s_mov_b32 s52, s16
s_mov_b32 s53, s17
s_mov_b32 s54, 0x380
s_mov_b32 s55, 0x20000
s_mov_b32 s56, s34
s_mov_b32 s57, s35
s_mov_b32 s58, 0x380
s_mov_b32 s59, 0x20000
v_mov_b32 v18, 0x80000000
s_mul_i32 s11, s2, 4352
s_add_u32 s11, s11, 1572864
s_lshl_b32 s13, s2, 3
v_lshrrev_b32 v2, 4, v1
v_lshlrev_b32 v2, 1, v2
v_and_b32 v3, 15, v1
v_cmp_eq_u32 vcc, 0, v3
s_nop 1
v_cndmask_b32 v3, v18, v2, vcc
buffer_load_ushort v4, v2, s[52:55], s13 offen
v_mov_b32 v10, v17
s_mov_b64 s[60:61], -1
v_mov_b32 v11, v17
s_mov_b64 s[62:63], -1
v_mov_b32 v12, v17
s_mov_b64 s[64:65], -1
v_mov_b32 v13, v17
s_mov_b64 s[66:67], -1
s_mov_b32 s96, 200000
s_barrier
red_spin:
buffer_load_dwordx4 v[80:83], v10, s[48:51], s11 offen offset:0 sc1
buffer_load_dwordx4 v[84:87], v11, s[48:51], s11 offen offset:1024 sc1
buffer_load_dwordx4 v[88:91], v12, s[48:51], s11 offen offset:2048 sc1
buffer_load_dwordx4 v[92:95], v13, s[48:51], s11 offen offset:3072 sc1
s_waitcnt vmcnt(0)
s_mov_b64 exec, s[60:61]
s_cbranch_execz red_skip0
v_perm_b32 v40, v81, v80, s76
v_perm_b32 v41, v83, v82, s77
v_or_b32 v40, v40, v41
v_xor_b32 v40, v40, v55
v_cmp_eq_u32 vcc, 0, v40
s_nop 0
s_andn2_b64 s[60:61], exec, vcc
s_and_b64 exec, exec, vcc
v_and_b32 v64, 0xffffff00, v80
v_and_b32 v65, 0xffffff00, v81
v_and_b32 v66, 0xffffff00, v82
v_and_b32 v67, 0xffffff00, v83
v_mov_b32 v10, v18
red_skip0:
s_mov_b64 exec, s[62:63]
s_cbranch_execz red_skip1
v_perm_b32 v40, v85, v84, s76
v_perm_b32 v41, v87, v86, s77
v_or_b32 v40, v40, v41
v_xor_b32 v40, v40, v55
v_cmp_eq_u32 vcc, 0, v40
s_nop 0
s_andn2_b64 s[62:63], exec, vcc
s_and_b64 exec, exec, vcc
v_and_b32 v68, 0xffffff00, v84
v_and_b32 v69, 0xffffff00, v85
v_and_b32 v70, 0xffffff00, v86
v_and_b32 v71, 0xffffff00, v87
v_mov_b32 v11, v18
red_skip1:
s_mov_b64 exec, s[64:65]
s_cbranch_execz red_skip2
v_perm_b32 v40, v89, v88, s76
v_perm_b32 v41, v91, v90, s77
v_or_b32 v40, v40, v41
v_xor_b32 v40, v40, v55
v_cmp_eq_u32 vcc, 0, v40
s_nop 0
s_andn2_b64 s[64:65], exec, vcc
s_and_b64 exec, exec, vcc
v_and_b32 v72, 0xffffff00, v88
v_and_b32 v73, 0xffffff00, v89
v_and_b32 v74, 0xffffff00, v90
v_and_b32 v75, 0xffffff00, v91
v_mov_b32 v12, v18
red_skip2:
s_mov_b64 exec, s[66:67]
s_cbranch_execz red_skip3
v_perm_b32 v40, v93, v92, s76
v_perm_b32 v41, v95, v94, s77
v_or_b32 v40, v40, v41
v_xor_b32 v40, v40, v55
v_cmp_eq_u32 vcc, 0, v40
s_nop 0
s_andn2_b64 s[66:67], exec, vcc
s_and_b64 exec, exec, vcc
v_and_b32 v76, 0xffffff00, v92
v_and_b32 v77, 0xffffff00, v93
v_and_b32 v78, 0xffffff00, v94
v_and_b32 v79, 0xffffff00, v95
v_mov_b32 v13, v18
red_skip3:
s_mov_b64 exec, -1
s_or_b64 s[80:81], s[60:61], s[62:63]
s_or_b64 s[82:83], s[64:65], s[66:67]
s_or_b64 s[80:81], s[80:81], s[82:83]
s_cbranch_scc0 red_ok
s_sub_u32 s96, s96, 1
s_cmp_lg_u32 s96, 0
s_cbranch_scc1 red_spin
red_ok:
v_add_f32 v64, v64, v68
v_add_f32 v72, v72, v76
v_add_f32 v65, v65, v69
v_add_f32 v73, v73, v77
v_add_f32 v66, v66, v70
v_add_f32 v74, v74, v78
v_add_f32 v67, v67, v71
v_add_f32 v75, v75, v79
v_add_f32 v64, v64, v72
v_add_f32 v65, v65, v73
v_add_f32 v66, v66, v74
v_add_f32 v67, v67, v75
s_nop 0
v_permlane32_swap_b32 v64, v66
v_permlane32_swap_b32 v65, v67
v_add_f32 v64, v64, v66
v_add_f32 v65, v65, v67
s_nop 1
v_permlane16_swap_b32 v64, v65
v_add_f32 v64, v64, v65
s_nop 1
v_add_f32_dpp v64, v64, v64 row_ror:8 row_mask:0xf bank_mask:0xf
s_nop 1
v_add_f32_dpp v64, v64, v64 row_ror:4 row_mask:0xf bank_mask:0xf
s_nop 1
v_add_f32_dpp v64, v64, v64 row_ror:2 row_mask:0xf bank_mask:0xf
s_nop 1
v_add_f32_dpp v64, v64, v64 row_ror:1 row_mask:0xf bank_mask:0xf
v_lshlrev_b32 v4, 16, v4
v_add_f32 v64, v64, v4
v_cvt_pk_bf16_f32 v64, v64, v64
buffer_store_short v64, v3, s[56:59], s13 offen
s_cmp_lg_u32 s2, 0
s_cbranch_scc1 main_fin
s_mov_b32 s8, 3112960
v_cmp_eq_u32 vcc, 0, v1
s_nop 1
v_cndmask_b32 v3, v18, v1, vcc
buffer_store_dword v55, v3, s[48:51], s8 offen
s_branch main_fin
tail0:
ds_read_b64 v[28:29], v16 offset:512
ds_read_b64 v[36:37], v16 offset:528
ds_read_b128 v[160:163], v15 offset:2048
v_and_b32 v44, 15, v1
v_lshlrev_b32 v45, 7, v44
v_and_b32 v47, 48, v1
v_add_u32 v44, v45, v47
s_lshl_b32 s15, s2, 11
s_add_u32 s15, s15, 2097152
s_waitcnt lgkmcnt(1)
v_max_f32 v52, v28, v29
v_sub_f32 v28, v28, v52
v_sub_f32 v29, v29, v52
v_mul_f32 v28, s88, v28
v_mul_f32 v29, s88, v29
v_exp_f32 v28, v28
v_exp_f32 v29, v29
v_mul_f32 v53, v28, v36
v_fmac_f32 v53, v29, v37
v_mul_f32 v48, v28, v48
v_mul_f32 v49, v28, v49
v_mul_f32 v50, v28, v50
v_mul_f32 v51, v28, v51
s_waitcnt lgkmcnt(0)
v_fmac_f32 v48, v29, v160
v_fmac_f32 v49, v29, v161
v_fmac_f32 v50, v29, v162
v_fmac_f32 v51, v29, v163
v_perm_b32 v48, v48, v55, s72
v_perm_b32 v49, v49, v55, s73
v_perm_b32 v50, v50, v55, s74
v_perm_b32 v51, v51, v55, s75
buffer_store_dwordx4 v[48:51], v56, s[48:51], s80 offen sc1
buffer_store_dwordx4 v[52:55], v57, s[48:51], s81 offen sc1
buffer_load_dwordx4 v[24:27], v44, s[48:51], s15 offen sc1
buffer_load_dwordx4 v[28:31], v45, s[48:51], s15 offen offset:64 sc1
v_and_b32 v14, 15, v1
v_and_b32 v15, 1, v1
v_lshlrev_b32 v15, 4, v15
v_mov_b32 v20, 0xffff
v_lshlrev_b32 v15, v15, v20
v_lshrrev_b32 v14, 1, v14
v_cmp_eq_u32 vcc, 0, v14
s_nop 1
v_cndmask_b32 v20, 0, v15, vcc
v_cmp_eq_u32 vcc, 1, v14
s_nop 1
v_cndmask_b32 v21, 0, v15, vcc
v_cmp_eq_u32 vcc, 2, v14
s_nop 1
v_cndmask_b32 v22, 0, v15, vcc
v_cmp_eq_u32 vcc, 3, v14
s_nop 1
v_cndmask_b32 v23, 0, v15, vcc
s_cmp_lt_u32 s2, 224
s_cselect_b32 s9, -1, 0
s_waitcnt vmcnt(4)
s_mov_b32 s96, 200000
gu_chk:
v_xor_b32 v40, s89, v43
v_xor_b32 v41, s89, v33
v_or_b32 v40, v40, v41
v_and_b32 v40, s9, v40
v_cmp_ne_u32 vcc, 0, v40
s_cbranch_vccz gu_ok
s_sub_u32 s96, s96, 1
s_cmp_eq_u32 s96, 0
s_cbranch_scc1 gu_ok
s_sleep 2
buffer_load_dwordx2 v[42:43], v18, s[48:51], s12 offen sc1
buffer_load_dwordx2 v[32:33], v18, s[48:51], s12 offen offset:512 sc1
s_waitcnt vmcnt(0)
s_branch gu_chk
gu_ok:
v_and_b32 v42, s9, v42
v_and_b32 v32, s9, v32
s_nop 0
v_add_f32_dpp v176, v42, v42 row_shl:4 row_mask:0xf bank_mask:0x5
v_add_f32_dpp v176, v42, v42 row_shr:4 row_mask:0xf bank_mask:0xa
v_add_f32_dpp v177, v32, v32 row_shl:4 row_mask:0xf bank_mask:0x5
v_add_f32_dpp v177, v32, v32 row_shr:4 row_mask:0xf bank_mask:0xa
v_add_f32_dpp v176, v176, v176 quad_perm:[2,3,0,1] row_mask:0xf bank_mask:0xf
s_nop 0
v_add_f32_dpp v177, v177, v177 quad_perm:[2,3,0,1] row_mask:0xf bank_mask:0xf
v_add_f32_dpp v176, v176, v176 quad_perm:[1,0,3,2] row_mask:0xf bank_mask:0xf
s_nop 0
v_add_f32_dpp v177, v177, v177 quad_perm:[1,0,3,2] row_mask:0xf bank_mask:0xf
v_cvt_pk_bf16_f32 v176, v176, v176
v_and_b32 v176, 0xffff0000, v176
v_cvt_pk_bf16_f32 v177, v177, v177
v_and_b32 v177, 0xffff0000, v177
v_mul_f32 v8, v176, v176
v_mul_f32 v8, v8, v176
v_mul_f32 v8, 0x3d372713, v8
v_add_f32 v8, v8, v176
v_mul_f32 v8, 0x3f4c422a, v8
v_mul_f32 v8, 0x4038aa3b, v8
v_exp_f32 v8, v8
s_nop 0
v_add_f32 v8, 1.0, v8
v_rcp_f32 v8, v8
s_nop 0
v_fma_f32 v8, v8, -2.0, 2.0
v_mul_f32 v9, 0.5, v176
v_mul_f32 v8, v8, v9
v_cvt_pk_bf16_f32 v8, v8, v8
v_and_b32 v8, 0xffff0000, v8
v_mul_f32 v8, v8, v177
v_cvt_pk_bf16_f32 v8, v8, v8
s_nop 1
v_and_b32_dpp v176, v8, v20 row_newbcast:0 row_mask:0xf bank_mask:0xf
v_and_b32_dpp v177, v8, v21 row_newbcast:0 row_mask:0xf bank_mask:0xf
v_and_b32_dpp v178, v8, v22 row_newbcast:0 row_mask:0xf bank_mask:0xf
v_and_b32_dpp v179, v8, v23 row_newbcast:0 row_mask:0xf bank_mask:0xf
v_and_b32_dpp v180, v8, v20 row_newbcast:8 row_mask:0xf bank_mask:0xf
v_and_b32_dpp v181, v8, v21 row_newbcast:8 row_mask:0xf bank_mask:0xf
v_and_b32_dpp v182, v8, v22 row_newbcast:8 row_mask:0xf bank_mask:0xf
v_and_b32_dpp v183, v8, v23 row_newbcast:8 row_mask:0xf bank_mask:0xf
v_mfma_f32_16x16x32_bf16 v[160:163], v[176:179], v[192:195], 0
v_mfma_f32_16x16x32_bf16 v[164:167], v[176:179], v[196:199], 0
v_mfma_f32_16x16x32_bf16 v[168:171], v[176:179], v[200:203], 0
v_mfma_f32_16x16x32_bf16 v[172:175], v[176:179], v[204:207], 0
v_mfma_f32_16x16x32_bf16 v[160:163], v[180:183], v[208:211], v[160:163]
v_mfma_f32_16x16x32_bf16 v[164:167], v[180:183], v[212:215], v[164:167]
v_mfma_f32_16x16x32_bf16 v[168:171], v[180:183], v[216:219], v[168:171]
v_mfma_f32_16x16x32_bf16 v[172:175], v[180:183], v[220:223], v[172:175]
s_mov_b32 s96, 200000
t0_spin:
s_waitcnt vmcnt(0)
v_perm_b32 v40, v25, v24, s76
v_perm_b32 v41, v27, v26, s77
v_or_b32 v40, v40, v41
v_xor_b32 v40, v40, v55
v_xor_b32 v41, v31, v55
v_or_b32 v40, v40, v41
v_cmp_eq_u32 vcc, 0, v40
s_nop 0
s_andn2_b64 s[78:79], exec, vcc
s_and_b64 exec, exec, vcc
v_and_b32 v32, 0xffffff00, v24
v_and_b32 v33, 0xffffff00, v25
v_and_b32 v34, 0xffffff00, v26
v_and_b32 v35, 0xffffff00, v27
v_mov_b32 v36, v28
v_mov_b32 v37, v29
s_mov_b64 exec, s[78:79]
s_cbranch_execz t0_ok
buffer_load_dwordx4 v[24:27], v44, s[48:51], s15 offen sc1
buffer_load_dwordx4 v[28:31], v45, s[48:51], s15 offen offset:64 sc1
s_sub_u32 s96, s96, 1
s_cmp_lg_u32 s96, 0
s_cbranch_scc1 t0_spin
t0_ok:
s_mov_b64 exec, -1
s_barrier
v_max_f32_dpp v38, v36, v36 row_ror:8 row_mask:0xf bank_mask:0xf
s_nop 1
v_max_f32_dpp v38, v38, v38 row_ror:4 row_mask:0xf bank_mask:0xf
s_nop 1
v_max_f32_dpp v38, v38, v38 row_ror:2 row_mask:0xf bank_mask:0xf
s_nop 1
v_max_f32_dpp v38, v38, v38 row_ror:1 row_mask:0xf bank_mask:0xf
v_sub_f32 v36, v36, v38
v_mul_f32 v36, s88, v36
v_exp_f32 v36, v36
s_nop 0
v_mul_f32 v32, v32, v36
v_mul_f32 v33, v33, v36
v_mul_f32 v34, v34, v36
v_mul_f32 v35, v35, v36
v_mul_f32 v36, v36, v37
s_nop 1
v_add_f32_dpp v36, v36, v36 row_ror:8 row_mask:0xf bank_mask:0xf
v_add_f32_dpp v32, v32, v32 row_ror:8 row_mask:0xf bank_mask:0xf
v_add_f32_dpp v33, v33, v33 row_ror:8 row_mask:0xf bank_mask:0xf
v_add_f32_dpp v34, v34, v34 row_ror:8 row_mask:0xf bank_mask:0xf
v_add_f32_dpp v35, v35, v35 row_ror:8 row_mask:0xf bank_mask:0xf
v_add_f32_dpp v36, v36, v36 row_ror:4 row_mask:0xf bank_mask:0xf
v_add_f32_dpp v32, v32, v32 row_ror:4 row_mask:0xf bank_mask:0xf
v_add_f32_dpp v33, v33, v33 row_ror:4 row_mask:0xf bank_mask:0xf
v_add_f32_dpp v34, v34, v34 row_ror:4 row_mask:0xf bank_mask:0xf
v_add_f32_dpp v35, v35, v35 row_ror:4 row_mask:0xf bank_mask:0xf
v_add_f32_dpp v36, v36, v36 row_ror:2 row_mask:0xf bank_mask:0xf
v_add_f32_dpp v32, v32, v32 row_ror:2 row_mask:0xf bank_mask:0xf
v_add_f32_dpp v33, v33, v33 row_ror:2 row_mask:0xf bank_mask:0xf
v_add_f32_dpp v34, v34, v34 row_ror:2 row_mask:0xf bank_mask:0xf
v_add_f32_dpp v35, v35, v35 row_ror:2 row_mask:0xf bank_mask:0xf
v_add_f32_dpp v36, v36, v36 row_ror:1 row_mask:0xf bank_mask:0xf
v_add_f32_dpp v32, v32, v32 row_ror:1 row_mask:0xf bank_mask:0xf
v_add_f32_dpp v33, v33, v33 row_ror:1 row_mask:0xf bank_mask:0xf
v_add_f32_dpp v34, v34, v34 row_ror:1 row_mask:0xf bank_mask:0xf
v_add_f32_dpp v35, v35, v35 row_ror:1 row_mask:0xf bank_mask:0xf
v_rcp_f32 v37, v36
s_nop 0
v_mul_f32 v32, v32, v37
v_mul_f32 v33, v33, v37
v_mul_f32 v34, v34, v37
v_mul_f32 v35, v35, v37
v_cvt_pk_bf16_f32 v32, v32, v32
v_cvt_pk_bf16_f32 v33, v33, v33
v_cvt_pk_bf16_f32 v34, v34, v34
v_cvt_pk_bf16_f32 v35, v35, v35
v_and_b32 v176, v32, v20
v_and_b32 v177, v32, v21
v_and_b32 v178, v32, v22
v_and_b32 v179, v32, v23
v_and_b32 v180, v33, v20
v_and_b32 v181, v33, v21
v_and_b32 v182, v33, v22
v_and_b32 v183, v33, v23
v_mfma_f32_16x16x32_bf16 v[160:163], v[176:179], v[64:67], v[160:163]
v_mfma_f32_16x16x32_bf16 v[164:167], v[176:179], v[68:71], v[164:167]
v_and_b32 v184, v34, v20
v_and_b32 v185, v34, v21
v_and_b32 v186, v34, v22
v_and_b32 v187, v34, v23
v_mfma_f32_16x16x32_bf16 v[168:171], v[176:179], v[72:75], v[168:171]
v_mfma_f32_16x16x32_bf16 v[172:175], v[176:179], v[76:79], v[172:175]
v_and_b32 v188, v35, v20
v_and_b32 v189, v35, v21
v_and_b32 v190, v35, v22
v_and_b32 v191, v35, v23
s_mov_b32 s8, s82
v_mfma_f32_16x16x32_bf16 v[160:163], v[180:183], v[80:83], v[160:163]
v_mfma_f32_16x16x32_bf16 v[160:163], v[184:187], v[96:99], v[160:163]
v_mfma_f32_16x16x32_bf16 v[160:163], v[188:191], v[112:115], v[160:163]
v_mfma_f32_16x16x32_bf16 v[164:167], v[180:183], v[84:87], v[164:167]
v_mfma_f32_16x16x32_bf16 v[164:167], v[184:187], v[100:103], v[164:167]
v_mfma_f32_16x16x32_bf16 v[164:167], v[188:191], v[116:119], v[164:167]
s_nop 4
v_perm_b32 v160, v160, v55, s72
v_perm_b32 v161, v161, v55, s73
v_perm_b32 v162, v162, v55, s74
v_perm_b32 v163, v163, v55, s75
buffer_store_dwordx4 v[160:163], v58, s[48:51], s8 offen sc1
s_add_u32 s8, s8, 139264
v_mfma_f32_16x16x32_bf16 v[168:171], v[180:183], v[88:91], v[168:171]
v_mfma_f32_16x16x32_bf16 v[168:171], v[184:187], v[104:107], v[168:171]
v_mfma_f32_16x16x32_bf16 v[168:171], v[188:191], v[120:123], v[168:171]
v_perm_b32 v164, v164, v55, s72
v_perm_b32 v165, v165, v55, s73
v_perm_b32 v166, v166, v55, s74
v_perm_b32 v167, v167, v55, s75
buffer_store_dwordx4 v[164:167], v58, s[48:51], s8 offen sc1
s_add_u32 s8, s8, 139264
v_mfma_f32_16x16x32_bf16 v[172:175], v[180:183], v[92:95], v[172:175]
v_mfma_f32_16x16x32_bf16 v[172:175], v[184:187], v[108:111], v[172:175]
v_mfma_f32_16x16x32_bf16 v[172:175], v[188:191], v[124:127], v[172:175]
v_perm_b32 v168, v168, v55, s72
v_perm_b32 v169, v169, v55, s73
v_perm_b32 v170, v170, v55, s74
v_perm_b32 v171, v171, v55, s75
buffer_store_dwordx4 v[168:171], v58, s[48:51], s8 offen sc1
s_add_u32 s8, s8, 139264
s_nop 1
v_perm_b32 v172, v172, v55, s72
v_perm_b32 v173, v173, v55, s73
v_perm_b32 v174, v174, v55, s74
v_perm_b32 v175, v175, v55, s75
buffer_store_dwordx4 v[172:175], v59, s[48:51], s8 offen sc1
main_fin:
main_done:
s_endpgm
v_share:
s_waitcnt lgkmcnt(0)
s_barrier
s_mov_b32 s13, 2
s_mov_b32 s14, 128
s_branch v_go
vt_spin:
s_sub_u32 s96, s96, 1
s_cmp_eq_u32 s96, 0
s_cbranch_scc1 vt_ok
s_sleep 8
buffer_load_dwordx4 v[60:63], v17, s[48:51], s12 offen sc1
s_waitcnt vmcnt(0)
s_branch vt_chk
code_end:
.section .rodata,"a"
.p2align 6
.amdhsa_kernel parallel_sum__mha_block_cached__geglu_ffn__decode_kernel
  .amdhsa_next_free_vgpr 224
  .amdhsa_next_free_sgpr 102
  .amdhsa_accum_offset 224
  .amdhsa_group_segment_fixed_size 0
  .amdhsa_kernarg_size 96
  .amdhsa_user_sgpr_count 2
  .amdhsa_user_sgpr_kernarg_segment_ptr 1
  .amdhsa_system_sgpr_workgroup_id_x 1
  .amdhsa_float_denorm_mode_32 3
.end_amdhsa_kernel
```
